```python
import torch

def _softmax(x, axis=-1):
    return torch.softmax(x, dim=axis)

def _gelu(x):
    return torch.nn.functional.gelu(x, approximate='tanh')

def _silu(x):
    return torch.nn.functional.silu(x)

def _sigmoid(x):
    return torch.sigmoid(x)

def _layernorm(x, axis=-1, eps=1e-05):
    m = x.mean(dim=axis, keepdim=True)
    v = x.var(dim=axis, keepdim=True, unbiased=False)
    return (x - m) / torch.sqrt(v + eps)

def _scatter_add(tgt, idx, src, axis=0):
    return tgt.clone().index_add_(axis, idx, src)

def _segment_sum(src, seg, n):
    out = torch.zeros((n,) + src.shape[1:], dtype=src.dtype)
    return out.index_add_(0, seg, src)

def _pad(x, pw):
    flat = tuple((v for pair in reversed(pw) for v in pair))
    return torch.nn.functional.pad(x, flat)
kernel_name = 'standalone__video_timesformer__vision'

def setup_inputs():

    _w = lambda a: (lambda t: t.to(torch.bfloat16) if t.is_floating_point() else t)(torch.as_tensor(a))
    T = 8
    p = 14
    HW = 384 // p * p
    N = (HW // p) ** 2
    C = 192
    return {'x': _w((lambda *s: torch.randn(*s, dtype=torch.bfloat16) * 0.05)(1, T, N, C)), 'wqkv_t': _w((lambda *s: torch.randn(*s, dtype=torch.bfloat16) * 0.05)(C, 3 * C)), 'wo_t': _w((lambda *s: torch.randn(*s, dtype=torch.bfloat16) * 0.05)(C, C)), 'wqkv_s': _w((lambda *s: torch.randn(*s, dtype=torch.bfloat16) * 0.05)(C, 3 * C)), 'wo_s': _w((lambda *s: torch.randn(*s, dtype=torch.bfloat16) * 0.4)(C, C))}

def reference(x, wqkv_t, wo_t, wqkv_s, wo_s):
    B, T, N, C = x.shape
    scale = C ** (-0.5)
    xt = (lambda x, *d: x.permute(*d))(x, 0, 2, 1, 3).reshape(B * N, T, C)
    h = _layernorm(xt, axis=-1)
    qkv = h @ wqkv_t
    q, k, v = (qkv[..., :C].clone(), qkv[..., C:2 * C].clone(), qkv[..., 2 * C:].clone())
    a = _softmax(torch.einsum('btc,bsc->bts', q, k) * scale, axis=-1)
    xt = xt + torch.einsum('bts,bsc->btc', a, v) @ wo_t
    x1 = (lambda x, *d: x.permute(*d))(xt.reshape(B, N, T, C), 0, 2, 1, 3)
    xs = x1.reshape(B * T, N, C)
    h = _layernorm(xs, axis=-1)
    qkv = h @ wqkv_s
    q, k, v = (qkv[..., :C].clone(), qkv[..., C:2 * C].clone(), qkv[..., 2 * C:].clone())
    a = _softmax(torch.einsum('bnc,bmc->bnm', q, k) * scale, axis=-1)
    xs = xs + torch.einsum('bnm,bmc->bnc', a, v) @ wo_s
    return xs.reshape(B, T, N, C)
```

```asm
; @launch kernel=tsf_temporal_kernel grid=(219,1,1) block=(256,1,1) lds=155648
; @launch kernel=tsf_spatial_kernel grid=(184,1,1) block=(256,1,1) lds=160768
.amdgcn_target "amdgcn-amd-amdhsa--gfx950"
.text
.globl tsf_temporal_kernel
.p2align 8
.type tsf_temporal_kernel,@function
tsf_temporal_kernel:
    s_cmp_ge_u32 s2, 219
    s_cbranch_scc1 K1_done
    s_load_dwordx16 s[4:19], s[0:1], 0
    v_and_b32 v1, 63, v0
    v_lshrrev_b32 v28, 6, v0
    v_and_b32 v2, 15, v0
    v_readfirstlane_b32 s36, v28
    v_bfe_u32 v3, v0, 4, 2
    s_lshl_b32 s38, s2, 2
    s_cmp_ge_u32 s2, 183
    s_cbranch_scc1 K1_side
    v_bfe_u32 v28, v0, 3, 2
    v_bfe_u32 v29, v0, 5, 3
    v_and_b32 v30, 7, v0
    v_add_u32 v34, s38, v28
    s_mov_b32 s41, 279936
    v_mul_lo_u32 v4, v29, s41
    v_mul_u32_u24 v32, 384, v34
    v_add_u32 v4, v4, v32
    v_lshl_add_u32 v27, v30, 4, v4
    v_lshlrev_b32 v35, 4, v1
    s_lshr_b32 s57, s2, 3
    s_mul_i32 s56, s57, 8
    s_add_u32 s56, s56, s36
    s_waitcnt lgkmcnt(0)
    s_mov_b32 s20, s4
    s_and_b32 s21, s5, 0xffff
    s_mov_b32 s22, 0x222c00
    s_mov_b32 s23, 0x20000
    buffer_load_dwordx4 v[36:39], v27, s[20:23], 0 offen offset:0 nt
    buffer_load_dwordx4 v[40:43], v27, s[20:23], 0 offen offset:128 nt
    buffer_load_dwordx4 v[44:47], v27, s[20:23], 0 offen offset:256 nt
    s_lshl_b32 s40, s57, 2
    s_add_u32 s40, s40, s36
    s_getpc_b64 s[58:59]
AL_pc_1:
    s_sub_u32 s58, s58, AL_pc_1-tsf_temporal_kernel
    s_subb_u32 s59, s59, 0
    s_lshl_b32 s40, s40, 10
    v_add_u32 v250, s40, v35
    v_min_u32 v250, TEXT_end-tsf_temporal_kernel-16, v250
    v_mov_b32 v251, s59
    v_add_co_u32 v250, vcc, s58, v250
    s_nop 1
    v_addc_co_u32 v251, vcc, 0, v251, vcc
    global_load_dwordx4 v[252:255], v[250:251], off
    s_mov_b32 s24, s6
    s_and_b32 s25, s7, 0xffff
    s_mov_b32 s26, 0x36000
    s_mov_b32 s27, 0x20000
    s_mov_b32 s28, s8
    s_and_b32 s29, s9, 0xffff
    s_mov_b32 s30, 0x12000
    s_mov_b32 s31, 0x20000
    s_and_b32 s40, s36, 1
    s_lshl_b32 s40, s40, 2
    s_lshl_b32 s41, s36, 3
    v_add_u32 v31, 0, v1
    v_mul_u32_u24 v32, 171, v31
    v_lshrrev_b32 v32, 12, v32
    v_mul_u32_u24 v8, 24, v32
    v_sub_u32 v31, v31, v8
    v_and_or_b32 v8, v32, 2, s40
    v_xor_b32 v31, v31, v8
    v_lshlrev_b32 v31, 4, v31
    v_add_u32 v32, s41, v32
    v_mul_u32_u24 v11, 384, v32
    v_add_u32 v11, v11, v31
    v_mul_u32_u24 v32, 768, v32
    v_add_u32 v8, v11, v32
    v_add_u32 v31, 64, v1
    v_mul_u32_u24 v32, 171, v31
    v_lshrrev_b32 v32, 12, v32
    v_mul_u32_u24 v9, 24, v32
    v_sub_u32 v31, v31, v9
    v_and_or_b32 v9, v32, 2, s40
    v_xor_b32 v31, v31, v9
    v_lshlrev_b32 v31, 4, v31
    v_add_u32 v32, s41, v32
    v_mul_u32_u24 v12, 384, v32
    v_add_u32 v12, v12, v31
    v_mul_u32_u24 v32, 768, v32
    v_add_u32 v9, v12, v32
    v_subrev_u32 v9, 1024, v9
    v_add_u32 v31, 128, v1
    v_mul_u32_u24 v32, 171, v31
    v_lshrrev_b32 v32, 12, v32
    v_mul_u32_u24 v10, 24, v32
    v_sub_u32 v31, v31, v10
    v_and_or_b32 v10, v32, 2, s40
    v_xor_b32 v31, v31, v10
    v_lshlrev_b32 v31, 4, v31
    v_add_u32 v32, s41, v32
    v_mul_u32_u24 v13, 384, v32
    v_add_u32 v13, v13, v31
    v_mul_u32_u24 v32, 768, v32
    v_add_u32 v10, v13, v32
    v_subrev_u32 v10, 2048, v10
    s_mul_i32 s46, s36, 3072
    s_add_u32 m0, s46, 0
    s_mov_b32 s42, 0
    buffer_load_dwordx4 v8, s[24:27], s42 offen offset:0 lds
    buffer_load_dwordx4 v9, s[24:27], s42 offen offset:1024 lds
    buffer_load_dwordx4 v10, s[24:27], s42 offen offset:2048 lds
    s_add_u32 m0, s46, 12288
    s_mov_b32 s42, 384
    buffer_load_dwordx4 v8, s[24:27], s42 offen offset:0 lds
    buffer_load_dwordx4 v9, s[24:27], s42 offen offset:1024 lds
    buffer_load_dwordx4 v10, s[24:27], s42 offen offset:2048 lds
    s_cmp_lt_u32 s56, 216
    s_cselect_b32 s48, s24, s28
    s_cselect_b32 s49, s25, s29
    s_cselect_b32 s50, s26, s30
    s_cselect_b32 s51, s27, s31
    s_cselect_b32 s40, 0, 216
    s_sub_u32 s40, s56, s40
    s_lshl_b32 s40, s40, 10
    buffer_load_dwordx4 a[0:3], v35, s[48:51], s40 offen
    s_add_u32 s56, s56, 4
    s_cmp_lt_u32 s56, 216
    s_cselect_b32 s48, s24, s28
    s_cselect_b32 s49, s25, s29
    s_cselect_b32 s50, s26, s30
    s_cselect_b32 s51, s27, s31
    s_cselect_b32 s40, 0, 216
    s_sub_u32 s40, s56, s40
    s_lshl_b32 s40, s40, 10
    buffer_load_dwordx4 a[4:7], v35, s[48:51], s40 offen
    s_add_u32 s56, s56, 4
    s_mov_b32 s32, s18
    s_and_b32 s33, s19, 0xffff
    s_mov_b32 s34, 0x469800
    s_mov_b32 s35, 0x20000
    s_mov_b32 s37, 0x3f803f80
    s_mov_b32 s39, 0xffff0000
    v_lshl_add_u32 v32, v28, 3, v29
    v_bfe_u32 v33, v32, 1, 3
    v_xor_b32 v33, v33, v30
    v_mul_u32_u24 v5, 384, v32
    v_lshl_add_u32 v5, v33, 4, v5
    v_add_u32 v5, 122880, v5
    v_bfe_u32 v32, v34, 1, 1
    v_bfe_u32 v33, v34, 2, 2
    v_lshl_or_b32 v32, v32, 2, v33
    v_xor_b32 v32, v32, v30
    v_lshl_add_u32 v6, v32, 4, v4
    v_cmp_gt_u32 vcc, 729, v34
    v_mov_b32 v32, 0x7fffffff
    s_nop 0
    v_cndmask_b32 v6, v32, v6, vcc
    v_lshl_add_u32 v33, v29, 2, v28
    v_lshlrev_b32 v33, 3, v33
    s_lshl_b32 s40, s2, 8
    s_add_u32 s40, s40, 2239488
    v_add_u32 v7, s40, v33
    v_cmp_eq_u32 vcc, 0, v30
    v_lshrrev_b32 v28, 1, v2
    v_mul_u32_u24 v29, 384, v2
    v_cndmask_b32 v7, v32, v7, vcc
    v_add_u32 v29, 122880, v29
    v_add_u32 v32, 0, v3
    v_xor_b32 v32, v32, v28
    v_lshl_add_u32 v23, v32, 4, v29
    v_add_u32 v32, 4, v3
    v_xor_b32 v32, v32, v28
    v_lshl_add_u32 v24, v32, 4, v29
    s_mul_i32 s40, s36, 6
    v_lshrrev_b32 v30, 1, v3
    v_and_b32 v31, 1, v3
    v_lshl_add_u32 v31, v31, 3, v29
    s_add_u32 s41, s40, 0
    v_add_u32 v32, s41, v30
    v_xor_b32 v32, v32, v28
    v_lshl_add_u32 v20, v32, 4, v31
    s_add_u32 s41, s40, 2
    v_add_u32 v32, s41, v30
    v_xor_b32 v32, v32, v28
    v_lshl_add_u32 v21, v32, 4, v31
    s_add_u32 s41, s40, 4
    v_add_u32 v32, s41, v30
    v_xor_b32 v32, v32, v28
    v_lshl_add_u32 v22, v32, 4, v31
    v_lshrrev_b32 v28, 2, v2
    v_lshl_add_u32 v29, v3, 3, v28
    v_mul_u32_u24 v29, 384, v29
    v_and_b32 v28, 2, v28
    v_and_b32 v30, 1, v3
    v_lshl_or_b32 v28, v30, 2, v28
    v_bfe_u32 v30, v0, 1, 1
    v_and_b32 v31, 1, v0
    v_lshl_add_u32 v31, v31, 3, v29
    s_add_u32 s41, s40, 0
    v_add_u32 v32, s41, v30
    v_xor_b32 v32, v32, v28
    v_lshl_add_u32 v14, v32, 4, v31
    v_add_u32 v17, 61440, v14
    s_add_u32 s41, s40, 2
    v_add_u32 v32, s41, v30
    v_xor_b32 v32, v32, v28
    v_lshl_add_u32 v15, v32, 4, v31
    v_add_u32 v18, 61440, v15
    s_add_u32 s41, s40, 4
    v_add_u32 v32, s41, v30
    v_xor_b32 v32, v32, v28
    v_lshl_add_u32 v16, v32, 4, v31
    v_add_u32 v19, 61440, v16
    v_lshlrev_b32 v25, 4, v1
    v_add_u32 v25, 147456, v25
    s_lshl_b32 s41, s36, 11
    v_add_u32 v26, s41, v25
    v_lshrrev_b32 v28, 1, v3
    v_lshrrev_b32 v29, 3, v2
    v_cmp_eq_u32 s[44:45], v28, v29
    s_waitcnt vmcnt(11)
    v_dot2_f32_bf16 v60, v36, s37, 0
    v_dot2_f32_bf16 v62, v36, v36, 0
    v_dot2_f32_bf16 v61, v37, s37, 0
    v_dot2_f32_bf16 v63, v37, v37, 0
    v_dot2_f32_bf16 v60, v38, s37, v60
    v_dot2_f32_bf16 v62, v38, v38, v62
    v_dot2_f32_bf16 v61, v39, s37, v61
    v_dot2_f32_bf16 v63, v39, v39, v63
    s_waitcnt vmcnt(10)
    v_dot2_f32_bf16 v60, v40, s37, v60
    v_dot2_f32_bf16 v62, v40, v40, v62
    v_dot2_f32_bf16 v61, v41, s37, v61
    v_dot2_f32_bf16 v63, v41, v41, v63
    v_dot2_f32_bf16 v60, v42, s37, v60
    v_dot2_f32_bf16 v62, v42, v42, v62
    v_dot2_f32_bf16 v61, v43, s37, v61
    v_dot2_f32_bf16 v63, v43, v43, v63
    s_waitcnt vmcnt(9)
    v_dot2_f32_bf16 v60, v44, s37, v60
    v_dot2_f32_bf16 v62, v44, v44, v62
    v_dot2_f32_bf16 v61, v45, s37, v61
    v_dot2_f32_bf16 v63, v45, v45, v63
    s_add_u32 m0, s46, 24576
    s_mov_b32 s42, 36864
    buffer_load_dwordx4 v8, s[24:27], s42 offen offset:0 lds
    v_dot2_f32_bf16 v60, v46, s37, v60
    v_dot2_f32_bf16 v62, v46, v46, v62
    v_dot2_f32_bf16 v61, v47, s37, v61
    v_dot2_f32_bf16 v63, v47, v47, v63
    v_lshlrev_b32 v68, 16, v36
    v_and_b32 v69, s39, v36
    v_lshlrev_b32 v70, 16, v37
    v_add_f32 v60, v60, v61
    buffer_load_dwordx4 v9, s[24:27], s42 offen offset:1024 lds
    v_add_f32 v62, v62, v63
    v_and_b32 v71, s39, v37
    v_lshlrev_b32 v72, 16, v38
    v_add_f32_dpp v60, v60, v60 quad_perm:[1,0,3,2] row_mask:0xf bank_mask:0xf
    v_add_f32_dpp v62, v62, v62 quad_perm:[1,0,3,2] row_mask:0xf bank_mask:0xf
    v_and_b32 v73, s39, v38
    v_lshlrev_b32 v74, 16, v39
    v_add_f32_dpp v60, v60, v60 quad_perm:[2,3,0,1] row_mask:0xf bank_mask:0xf
    buffer_load_dwordx4 v10, s[24:27], s42 offen offset:2048 lds
    v_add_f32_dpp v62, v62, v62 quad_perm:[2,3,0,1] row_mask:0xf bank_mask:0xf
    v_and_b32 v75, s39, v39
    v_lshlrev_b32 v76, 16, v40
    v_add_f32_dpp v60, v60, v60 row_half_mirror row_mask:0xf bank_mask:0xf
    v_add_f32_dpp v62, v62, v62 row_half_mirror row_mask:0xf bank_mask:0xf
    v_and_b32 v77, s39, v40
    v_lshlrev_b32 v78, 16, v41
    v_mul_f32 v64, 0x3baaaaab, v60
    s_add_u32 m0, s46, 36864
    s_mov_b32 s42, 37248
    buffer_load_dwordx4 v8, s[24:27], s42 offen offset:0 lds
    v_mul_f32 v62, 0x3baaaaab, v62
    v_and_b32 v79, s39, v41
    v_fma_f32 v62, -v64, v64, v62
    v_lshlrev_b32 v80, 16, v42
    v_max_f32 v62, 0, v62
    v_and_b32 v81, s39, v42
    v_add_f32 v62, 0x3727c5ac, v62
    v_lshlrev_b32 v82, 16, v43
    buffer_load_dwordx4 v9, s[24:27], s42 offen offset:1024 lds
    v_rsq_f32 v66, v62
    v_and_b32 v83, s39, v43
    v_lshlrev_b32 v84, 16, v44
    v_and_b32 v85, s39, v44
    v_lshlrev_b32 v86, 16, v45
    v_and_b32 v87, s39, v45
    v_lshlrev_b32 v88, 16, v46
    v_and_b32 v89, s39, v46
    buffer_load_dwordx4 v10, s[24:27], s42 offen offset:2048 lds
    v_lshlrev_b32 v90, 16, v47
    v_and_b32 v91, s39, v47
    v_mul_f32 v67, v64, v66
    v_pk_fma_f32 v[68:69], v[68:69], v[66:67], v[66:67] op_sel:[0,0,1] op_sel_hi:[1,0,1] neg_lo:[0,0,1] neg_hi:[0,0,1]
    v_pk_fma_f32 v[70:71], v[70:71], v[66:67], v[66:67] op_sel:[0,0,1] op_sel_hi:[1,0,1] neg_lo:[0,0,1] neg_hi:[0,0,1]
    v_pk_fma_f32 v[72:73], v[72:73], v[66:67], v[66:67] op_sel:[0,0,1] op_sel_hi:[1,0,1] neg_lo:[0,0,1] neg_hi:[0,0,1]
    v_cvt_pk_bf16_f32 v48, v68, v69
    v_pk_fma_f32 v[74:75], v[74:75], v[66:67], v[66:67] op_sel:[0,0,1] op_sel_hi:[1,0,1] neg_lo:[0,0,1] neg_hi:[0,0,1]
    v_cvt_pk_bf16_f32 v49, v70, v71
    v_pk_fma_f32 v[76:77], v[76:77], v[66:67], v[66:67] op_sel:[0,0,1] op_sel_hi:[1,0,1] neg_lo:[0,0,1] neg_hi:[0,0,1]
    v_cvt_pk_bf16_f32 v50, v72, v73
    v_pk_fma_f32 v[78:79], v[78:79], v[66:67], v[66:67] op_sel:[0,0,1] op_sel_hi:[1,0,1] neg_lo:[0,0,1] neg_hi:[0,0,1]
    v_cvt_pk_bf16_f32 v51, v74, v75
    v_pk_fma_f32 v[80:81], v[80:81], v[66:67], v[66:67] op_sel:[0,0,1] op_sel_hi:[1,0,1] neg_lo:[0,0,1] neg_hi:[0,0,1]
    v_cvt_pk_bf16_f32 v52, v76, v77
    v_pk_fma_f32 v[82:83], v[82:83], v[66:67], v[66:67] op_sel:[0,0,1] op_sel_hi:[1,0,1] neg_lo:[0,0,1] neg_hi:[0,0,1]
    v_cvt_pk_bf16_f32 v53, v78, v79
    v_pk_fma_f32 v[84:85], v[84:85], v[66:67], v[66:67] op_sel:[0,0,1] op_sel_hi:[1,0,1] neg_lo:[0,0,1] neg_hi:[0,0,1]
    v_cvt_pk_bf16_f32 v54, v80, v81
    v_pk_fma_f32 v[86:87], v[86:87], v[66:67], v[66:67] op_sel:[0,0,1] op_sel_hi:[1,0,1] neg_lo:[0,0,1] neg_hi:[0,0,1]
    v_cvt_pk_bf16_f32 v55, v82, v83
    v_pk_fma_f32 v[88:89], v[88:89], v[66:67], v[66:67] op_sel:[0,0,1] op_sel_hi:[1,0,1] neg_lo:[0,0,1] neg_hi:[0,0,1]
    v_cvt_pk_bf16_f32 v56, v84, v85
    v_pk_fma_f32 v[90:91], v[90:91], v[66:67], v[66:67] op_sel:[0,0,1] op_sel_hi:[1,0,1] neg_lo:[0,0,1] neg_hi:[0,0,1]
    v_cvt_pk_bf16_f32 v57, v86, v87
    v_cvt_pk_bf16_f32 v58, v88, v89
    v_cvt_pk_bf16_f32 v59, v90, v91
    ds_write_b128 v5, v[48:51] offset:0
    ds_write_b128 v5, v[52:55] offset:128
    ds_write_b128 v5, v[56:59] offset:256
    s_waitcnt vmcnt(8)
    s_waitcnt lgkmcnt(0)
    s_barrier
    ds_read_b128 v[92:95], v23 offset:0
    ds_read_b128 v[116:119], v23 offset:6144
    s_add_u32 m0, s46, 49152
    s_mov_b32 s42, 73728
    buffer_load_dwordx4 v8, s[24:27], s42 offen offset:0 lds
    ds_read_b64_tr_b16 v[140:141], v14 offset:0
    ds_read_b64_tr_b16 v[142:143], v14 offset:1536
    ds_read_b64_tr_b16 v[144:145], v15 offset:0
    buffer_load_dwordx4 v9, s[24:27], s42 offen offset:1024 lds
    ds_read_b64_tr_b16 v[146:147], v15 offset:1536
    ds_read_b64_tr_b16 v[148:149], v16 offset:0
    buffer_load_dwordx4 v10, s[24:27], s42 offen offset:2048 lds
    ds_read_b64_tr_b16 v[150:151], v16 offset:1536
    ds_read_b64_tr_b16 v[152:153], v14 offset:12288
    s_add_u32 m0, s46, 61440
    s_mov_b32 s42, 74112
    buffer_load_dwordx4 v8, s[24:27], s42 offen offset:0 lds
    ds_read_b64_tr_b16 v[154:155], v14 offset:13824
    ds_read_b64_tr_b16 v[156:157], v15 offset:12288
    ds_read_b64_tr_b16 v[158:159], v15 offset:13824
    buffer_load_dwordx4 v9, s[24:27], s42 offen offset:1024 lds
    ds_read_b64_tr_b16 v[160:161], v16 offset:12288
    ds_read_b64_tr_b16 v[162:163], v16 offset:13824
    buffer_load_dwordx4 v10, s[24:27], s42 offen offset:2048 lds
    ds_read_b128 v[96:99], v24 offset:0
    ds_read_b128 v[120:123], v24 offset:6144
    s_add_u32 m0, s46, 73728
    s_mov_b32 s42, 110592
    buffer_load_dwordx4 v8, s[24:27], s42 offen offset:0 lds
    ds_read_b128 v[100:103], v23 offset:128
    buffer_load_dwordx4 v9, s[24:27], s42 offen offset:1024 lds
    ds_read_b128 v[124:127], v23 offset:6272
    ds_read_b128 v[104:107], v24 offset:128
    buffer_load_dwordx4 v10, s[24:27], s42 offen offset:2048 lds
    ds_read_b128 v[128:131], v24 offset:6272
    ds_read_b128 v[108:111], v23 offset:256
    s_add_u32 m0, s46, 86016
    s_mov_b32 s42, 110976
    buffer_load_dwordx4 v8, s[24:27], s42 offen offset:0 lds
    ds_read_b128 v[132:135], v23 offset:6400
    buffer_load_dwordx4 v9, s[24:27], s42 offen offset:1024 lds
    ds_read_b128 v[112:115], v24 offset:256
    ds_read_b128 v[136:139], v24 offset:6400
    buffer_load_dwordx4 v10, s[24:27], s42 offen offset:2048 lds
    s_waitcnt vmcnt(12)
    s_barrier
    s_waitcnt lgkmcnt(3)
    v_mfma_f32_16x16x32_bf16 v[188:191], v[140:143], v[92:95], 0
    ds_read_b64_tr_b16 v[164:165], v14 offset:24576
    v_mfma_f32_16x16x32_bf16 v[192:195], v[140:143], v[116:119], 0
    ds_read_b64_tr_b16 v[166:167], v14 offset:26112
    s_add_u32 m0, s46, 98304
    s_mov_b32 s42, 147456
    buffer_load_dwordx4 v8, s[24:27], s42 offen offset:0 lds
    v_mfma_f32_16x16x32_bf16 v[196:199], v[144:147], v[92:95], 0
    ds_read_b64_tr_b16 v[168:169], v15 offset:24576
    v_mfma_f32_16x16x32_bf16 v[200:203], v[144:147], v[116:119], 0
    ds_read_b64_tr_b16 v[170:171], v15 offset:26112
    buffer_load_dwordx4 v9, s[24:27], s42 offen offset:1024 lds
    v_mfma_f32_16x16x32_bf16 v[204:207], v[148:151], v[92:95], 0
    ds_read_b64_tr_b16 v[172:173], v16 offset:24576
    v_mfma_f32_16x16x32_bf16 v[208:211], v[148:151], v[116:119], 0
    ds_read_b64_tr_b16 v[174:175], v16 offset:26112
    buffer_load_dwordx4 v10, s[24:27], s42 offen offset:2048 lds
    v_mfma_f32_16x16x32_bf16 v[212:215], v[152:155], v[92:95], 0
    ds_read_b64_tr_b16 v[176:177], v14 offset:36864
    v_mfma_f32_16x16x32_bf16 v[216:219], v[152:155], v[116:119], 0
    ds_read_b64_tr_b16 v[178:179], v14 offset:38400
    s_add_u32 m0, s46, 110592
    s_mov_b32 s42, 147840
    buffer_load_dwordx4 v8, s[24:27], s42 offen offset:0 lds
    v_mfma_f32_16x16x32_bf16 v[220:223], v[156:159], v[92:95], 0
    ds_read_b64_tr_b16 v[180:181], v15 offset:36864
    v_mfma_f32_16x16x32_bf16 v[224:227], v[156:159], v[116:119], 0
    ds_read_b64_tr_b16 v[182:183], v15 offset:38400
    buffer_load_dwordx4 v9, s[24:27], s42 offen offset:1024 lds
    v_mfma_f32_16x16x32_bf16 v[228:231], v[160:163], v[92:95], 0
    ds_read_b64_tr_b16 v[184:185], v16 offset:36864
    v_mfma_f32_16x16x32_bf16 v[232:235], v[160:163], v[116:119], 0
    ds_read_b64_tr_b16 v[186:187], v16 offset:38400
    buffer_load_dwordx4 v10, s[24:27], s42 offen offset:2048 lds
    s_waitcnt vmcnt(12)
    s_barrier
    s_waitcnt lgkmcnt(3)
    v_mfma_f32_16x16x32_bf16 v[188:191], v[164:167], v[96:99], v[188:191]
    ds_read_b64_tr_b16 v[140:141], v14 offset:49152
    v_mfma_f32_16x16x32_bf16 v[192:195], v[164:167], v[120:123], v[192:195]
    ds_read_b64_tr_b16 v[142:143], v14 offset:50688
    s_add_u32 m0, s46, 0
    s_mov_b32 s42, 184320
    buffer_load_dwordx4 v8, s[24:27], s42 offen offset:0 lds
    v_mfma_f32_16x16x32_bf16 v[196:199], v[168:171], v[96:99], v[196:199]
    ds_read_b64_tr_b16 v[144:145], v15 offset:49152
    v_mfma_f32_16x16x32_bf16 v[200:203], v[168:171], v[120:123], v[200:203]
    ds_read_b64_tr_b16 v[146:147], v15 offset:50688
    buffer_load_dwordx4 v9, s[24:27], s42 offen offset:1024 lds
    v_mfma_f32_16x16x32_bf16 v[204:207], v[172:175], v[96:99], v[204:207]
    ds_read_b64_tr_b16 v[148:149], v16 offset:49152
    v_mfma_f32_16x16x32_bf16 v[208:211], v[172:175], v[120:123], v[208:211]
    ds_read_b64_tr_b16 v[150:151], v16 offset:50688
    buffer_load_dwordx4 v10, s[24:27], s42 offen offset:2048 lds
    v_mfma_f32_16x16x32_bf16 v[212:215], v[176:179], v[96:99], v[212:215]
    ds_read_b64_tr_b16 v[152:153], v17 offset:0
    v_mfma_f32_16x16x32_bf16 v[216:219], v[176:179], v[120:123], v[216:219]
    ds_read_b64_tr_b16 v[154:155], v17 offset:1536
    s_add_u32 m0, s46, 12288
    s_mov_b32 s42, 184704
    buffer_load_dwordx4 v8, s[24:27], s42 offen offset:0 lds
    s_waitcnt lgkmcnt(3)
    v_mfma_f32_16x16x32_bf16 v[220:223], v[180:183], v[96:99], v[220:223]
    ds_read_b64_tr_b16 v[156:157], v18 offset:0
    v_mfma_f32_16x16x32_bf16 v[224:227], v[180:183], v[120:123], v[224:227]
    ds_read_b64_tr_b16 v[158:159], v18 offset:1536
    buffer_load_dwordx4 v9, s[24:27], s42 offen offset:1024 lds
    v_mfma_f32_16x16x32_bf16 v[228:231], v[184:187], v[96:99], v[228:231]
    ds_read_b64_tr_b16 v[160:161], v19 offset:0
    v_mfma_f32_16x16x32_bf16 v[232:235], v[184:187], v[120:123], v[232:235]
    ds_read_b64_tr_b16 v[162:163], v19 offset:1536
    buffer_load_dwordx4 v10, s[24:27], s42 offen offset:2048 lds
    s_waitcnt vmcnt(12)
    s_barrier
    v_mfma_f32_16x16x32_bf16 v[188:191], v[140:143], v[100:103], v[188:191]
    ds_read_b64_tr_b16 v[164:165], v17 offset:12288
    v_mfma_f32_16x16x32_bf16 v[192:195], v[140:143], v[124:127], v[192:195]
    ds_read_b64_tr_b16 v[166:167], v17 offset:13824
    s_add_u32 m0, s46, 24576
    s_mov_b32 s42, 768
    buffer_load_dwordx4 v8, s[24:27], s42 offen offset:0 lds
    v_mfma_f32_16x16x32_bf16 v[196:199], v[144:147], v[100:103], v[196:199]
    ds_read_b64_tr_b16 v[168:169], v18 offset:12288
    v_mfma_f32_16x16x32_bf16 v[200:203], v[144:147], v[124:127], v[200:203]
    ds_read_b64_tr_b16 v[170:171], v18 offset:13824
    buffer_load_dwordx4 v9, s[24:27], s42 offen offset:1024 lds
    s_waitcnt lgkmcnt(3)
    v_mfma_f32_16x16x32_bf16 v[204:207], v[148:151], v[100:103], v[204:207]
    ds_read_b64_tr_b16 v[172:173], v19 offset:12288
    v_mfma_f32_16x16x32_bf16 v[208:211], v[148:151], v[124:127], v[208:211]
    ds_read_b64_tr_b16 v[174:175], v19 offset:13824
    buffer_load_dwordx4 v10, s[24:27], s42 offen offset:2048 lds
    v_mfma_f32_16x16x32_bf16 v[212:215], v[152:155], v[100:103], v[212:215]
    ds_read_b64_tr_b16 v[176:177], v17 offset:24576
    v_mfma_f32_16x16x32_bf16 v[216:219], v[152:155], v[124:127], v[216:219]
    ds_read_b64_tr_b16 v[178:179], v17 offset:26112
    s_add_u32 m0, s46, 36864
    s_mov_b32 s42, 37632
    buffer_load_dwordx4 v8, s[24:27], s42 offen offset:0 lds
    v_mfma_f32_16x16x32_bf16 v[220:223], v[156:159], v[100:103], v[220:223]
    ds_read_b64_tr_b16 v[180:181], v18 offset:24576
    v_mfma_f32_16x16x32_bf16 v[224:227], v[156:159], v[124:127], v[224:227]
    ds_read_b64_tr_b16 v[182:183], v18 offset:26112
    buffer_load_dwordx4 v9, s[24:27], s42 offen offset:1024 lds
    v_mfma_f32_16x16x32_bf16 v[228:231], v[160:163], v[100:103], v[228:231]
    ds_read_b64_tr_b16 v[184:185], v19 offset:24576
    v_mfma_f32_16x16x32_bf16 v[232:235], v[160:163], v[124:127], v[232:235]
    ds_read_b64_tr_b16 v[186:187], v19 offset:26112
    buffer_load_dwordx4 v10, s[24:27], s42 offen offset:2048 lds
    s_waitcnt vmcnt(12)
    s_barrier
    s_waitcnt lgkmcnt(3)
    v_mfma_f32_16x16x32_bf16 v[188:191], v[164:167], v[104:107], v[188:191]
    ds_read_b64_tr_b16 v[140:141], v17 offset:36864
    v_mfma_f32_16x16x32_bf16 v[192:195], v[164:167], v[128:131], v[192:195]
    ds_read_b64_tr_b16 v[142:143], v17 offset:38400
    s_add_u32 m0, s46, 49152
    s_mov_b32 s42, 74496
    buffer_load_dwordx4 v8, s[24:27], s42 offen offset:0 lds
    v_mfma_f32_16x16x32_bf16 v[196:199], v[168:171], v[104:107], v[196:199]
    ds_read_b64_tr_b16 v[144:145], v18 offset:36864
    v_mfma_f32_16x16x32_bf16 v[200:203], v[168:171], v[128:131], v[200:203]
    ds_read_b64_tr_b16 v[146:147], v18 offset:38400
    buffer_load_dwordx4 v9, s[24:27], s42 offen offset:1024 lds
    v_mfma_f32_16x16x32_bf16 v[204:207], v[172:175], v[104:107], v[204:207]
    ds_read_b64_tr_b16 v[148:149], v19 offset:36864
    v_mfma_f32_16x16x32_bf16 v[208:211], v[172:175], v[128:131], v[208:211]
    ds_read_b64_tr_b16 v[150:151], v19 offset:38400
    buffer_load_dwordx4 v10, s[24:27], s42 offen offset:2048 lds
    v_mfma_f32_16x16x32_bf16 v[212:215], v[176:179], v[104:107], v[212:215]
    ds_read_b64_tr_b16 v[152:153], v17 offset:49152
    v_mfma_f32_16x16x32_bf16 v[216:219], v[176:179], v[128:131], v[216:219]
    ds_read_b64_tr_b16 v[154:155], v17 offset:50688
    s_add_u32 m0, s46, 61440
    s_mov_b32 s42, 111360
    buffer_load_dwordx4 v8, s[24:27], s42 offen offset:0 lds
    s_waitcnt lgkmcnt(3)
    v_mfma_f32_16x16x32_bf16 v[220:223], v[180:183], v[104:107], v[220:223]
    ds_read_b64_tr_b16 v[156:157], v18 offset:49152
    v_mfma_f32_16x16x32_bf16 v[224:227], v[180:183], v[128:131], v[224:227]
    ds_read_b64_tr_b16 v[158:159], v18 offset:50688
    buffer_load_dwordx4 v9, s[24:27], s42 offen offset:1024 lds
    v_mfma_f32_16x16x32_bf16 v[228:231], v[184:187], v[104:107], v[228:231]
    ds_read_b64_tr_b16 v[160:161], v19 offset:49152
    v_mfma_f32_16x16x32_bf16 v[232:235], v[184:187], v[128:131], v[232:235]
    ds_read_b64_tr_b16 v[162:163], v19 offset:50688
    buffer_load_dwordx4 v10, s[24:27], s42 offen offset:2048 lds
    s_waitcnt vmcnt(12)
    s_barrier
    v_mfma_f32_16x16x32_bf16 v[188:191], v[140:143], v[108:111], v[188:191]
    ds_read_b64_tr_b16 v[164:165], v14 offset:0
    v_mfma_f32_16x16x32_bf16 v[192:195], v[140:143], v[132:135], v[192:195]
    ds_read_b64_tr_b16 v[166:167], v14 offset:1536
    s_add_u32 m0, s46, 73728
    s_mov_b32 s42, 148224
    buffer_load_dwordx4 v8, s[24:27], s42 offen offset:0 lds
    v_mfma_f32_16x16x32_bf16 v[196:199], v[144:147], v[108:111], v[196:199]
    ds_read_b64_tr_b16 v[168:169], v15 offset:0
    v_mfma_f32_16x16x32_bf16 v[200:203], v[144:147], v[132:135], v[200:203]
    ds_read_b64_tr_b16 v[170:171], v15 offset:1536
    buffer_load_dwordx4 v9, s[24:27], s42 offen offset:1024 lds
    s_waitcnt lgkmcnt(3)
    v_mfma_f32_16x16x32_bf16 v[204:207], v[148:151], v[108:111], v[204:207]
    ds_read_b64_tr_b16 v[172:173], v16 offset:0
    v_mfma_f32_16x16x32_bf16 v[208:211], v[148:151], v[132:135], v[208:211]
    ds_read_b64_tr_b16 v[174:175], v16 offset:1536
    buffer_load_dwordx4 v10, s[24:27], s42 offen offset:2048 lds
    v_mfma_f32_16x16x32_bf16 v[212:215], v[152:155], v[108:111], v[212:215]
    ds_read_b64_tr_b16 v[176:177], v14 offset:12288
    v_mfma_f32_16x16x32_bf16 v[216:219], v[152:155], v[132:135], v[216:219]
    ds_read_b64_tr_b16 v[178:179], v14 offset:13824
    s_add_u32 m0, s46, 86016
    s_mov_b32 s42, 185088
    buffer_load_dwordx4 v8, s[24:27], s42 offen offset:0 lds
    v_mfma_f32_16x16x32_bf16 v[220:223], v[156:159], v[108:111], v[220:223]
    ds_read_b64_tr_b16 v[180:181], v15 offset:12288
    v_mfma_f32_16x16x32_bf16 v[224:227], v[156:159], v[132:135], v[224:227]
    ds_read_b64_tr_b16 v[182:183], v15 offset:13824
    buffer_load_dwordx4 v9, s[24:27], s42 offen offset:1024 lds
    v_mfma_f32_16x16x32_bf16 v[228:231], v[160:163], v[108:111], v[228:231]
    ds_read_b64_tr_b16 v[184:185], v16 offset:12288
    v_mfma_f32_16x16x32_bf16 v[232:235], v[160:163], v[132:135], v[232:235]
    ds_read_b64_tr_b16 v[186:187], v16 offset:13824
    buffer_load_dwordx4 v10, s[24:27], s42 offen offset:2048 lds
    s_waitcnt lgkmcnt(4)
    v_mfma_f32_16x16x32_bf16 v[188:191], v[164:167], v[112:115], v[188:191]
    v_mfma_f32_16x16x32_bf16 v[192:195], v[164:167], v[136:139], v[192:195]
    v_mfma_f32_16x16x32_bf16 v[196:199], v[168:171], v[112:115], v[196:199]
    v_mfma_f32_16x16x32_bf16 v[200:203], v[168:171], v[136:139], v[200:203]
    v_mfma_f32_16x16x32_bf16 v[204:207], v[172:175], v[112:115], v[204:207]
    v_mfma_f32_16x16x32_bf16 v[208:211], v[172:175], v[136:139], v[208:211]
    v_mfma_f32_16x16x32_bf16 v[212:215], v[176:179], v[112:115], v[212:215]
    v_mfma_f32_16x16x32_bf16 v[216:219], v[176:179], v[136:139], v[216:219]
    s_waitcnt lgkmcnt(0)
    v_mfma_f32_16x16x32_bf16 v[220:223], v[180:183], v[112:115], v[220:223]
    v_mfma_f32_16x16x32_bf16 v[224:227], v[180:183], v[136:139], v[224:227]
    v_mfma_f32_16x16x32_bf16 v[228:231], v[184:187], v[112:115], v[228:231]
    v_mfma_f32_16x16x32_bf16 v[232:235], v[184:187], v[136:139], v[232:235]
    s_nop 1
    v_cvt_pk_bf16_f32 v48, v212, v213
    v_cvt_pk_bf16_f32 v49, v214, v215
    v_cvt_pk_bf16_f32 v52, v188, v189
    v_cvt_pk_bf16_f32 v53, v190, v191
    v_cvt_pk_bf16_f32 v50, v220, v221
    v_cvt_pk_bf16_f32 v51, v222, v223
    v_cvt_pk_bf16_f32 v54, v196, v197
    v_cvt_pk_bf16_f32 v55, v198, v199
    s_nop 1
    v_mfma_f32_16x16x32_bf16 v[240:243], v[48:51], v[52:55], 0
    v_cvt_pk_bf16_f32 v56, v228, v229
    v_cvt_pk_bf16_f32 v57, v230, v231
    v_cvt_pk_bf16_f32 v58, v204, v205
    v_cvt_pk_bf16_f32 v59, v206, v207
    v_cvt_pk_bf16_f32 v84, v216, v217
    v_cvt_pk_bf16_f32 v85, v218, v219
    v_cvt_pk_bf16_f32 v88, v192, v193
    v_cvt_pk_bf16_f32 v89, v194, v195
    v_cvt_pk_bf16_f32 v86, v224, v225
    v_cvt_pk_bf16_f32 v87, v226, v227
    v_cvt_pk_bf16_f32 v90, v200, v201
    v_cvt_pk_bf16_f32 v91, v202, v203
    s_nop 1
    v_mfma_f32_16x16x32_bf16 v[244:247], v[84:87], v[88:91], 0
    v_cvt_pk_bf16_f32 v248, v232, v233
    v_cvt_pk_bf16_f32 v249, v234, v235
    v_cvt_pk_bf16_f32 v250, v208, v209
    v_cvt_pk_bf16_f32 v251, v210, v211
    v_mfma_f32_16x16x16_bf16 v[240:243], v[56:57], v[58:59], v[240:243]
    s_nop 0
    v_mfma_f32_16x16x16_bf16 v[244:247], v[248:249], v[250:251], v[244:247]
    s_nop 5
    ds_write_b128 v26, v[240:243] offset:0
    s_nop 0
    ds_write_b128 v26, v[244:247] offset:1024
    s_waitcnt vmcnt(6)
    s_waitcnt lgkmcnt(0)
    s_barrier
    ds_read_b128 v[188:191], v25 offset:0
    ds_read_b128 v[196:199], v25 offset:2048
    ds_read_b128 v[204:207], v25 offset:4096
    ds_read_b128 v[212:215], v25 offset:6144
    ds_read_b128 v[192:195], v25 offset:1024
    s_add_u32 m0, s46, 98304
    s_mov_b32 s42, 0
    buffer_load_dwordx4 v11, s[28:31], s42 offen lds
    ds_read_b128 v[200:203], v25 offset:3072
    ds_read_b128 v[208:211], v25 offset:5120
    ds_read_b128 v[216:219], v25 offset:7168
    ds_read_b64_tr_b16 v[140:141], v14 offset:24576
    ds_read_b64_tr_b16 v[142:143], v14 offset:26112
    ds_read_b64_tr_b16 v[144:145], v15 offset:24576
    s_add_u32 m0, s46, 99328
    s_nop 0
    buffer_load_dwordx4 v12, s[28:31], s42 offen lds
    ds_read_b64_tr_b16 v[146:147], v15 offset:26112
    ds_read_b64_tr_b16 v[148:149], v16 offset:24576
    ds_read_b64_tr_b16 v[150:151], v16 offset:26112
    ds_read_b64_tr_b16 v[152:153], v14 offset:36864
    ds_read_b64_tr_b16 v[154:155], v14 offset:38400
    s_add_u32 m0, s46, 100352
    s_nop 0
    buffer_load_dwordx4 v13, s[28:31], s42 offen lds
    ds_read_b64_tr_b16 v[156:157], v15 offset:36864
    ds_read_b64_tr_b16 v[158:159], v15 offset:38400
    ds_read_b64_tr_b16 v[160:161], v16 offset:36864
    ds_read_b64_tr_b16 v[162:163], v16 offset:38400
    ds_read_b64_tr_b16 v[164:165], v14 offset:49152
    s_add_u32 m0, s46, 110592
    s_mov_b32 s42, 12288
    buffer_load_dwordx4 v11, s[28:31], s42 offen lds
    ds_read_b64_tr_b16 v[166:167], v14 offset:50688
    ds_read_b64_tr_b16 v[168:169], v15 offset:49152
    ds_read_b64_tr_b16 v[170:171], v15 offset:50688
    ds_read_b64_tr_b16 v[172:173], v16 offset:49152
    ds_read_b64_tr_b16 v[174:175], v16 offset:50688
    ds_read_b64_tr_b16 v[176:177], v17 offset:0
    s_add_u32 m0, s46, 111616
    s_nop 0
    buffer_load_dwordx4 v12, s[28:31], s42 offen lds
    ds_read_b64_tr_b16 v[178:179], v17 offset:1536
    ds_read_b64_tr_b16 v[180:181], v18 offset:0
    ds_read_b64_tr_b16 v[182:183], v18 offset:1536
    ds_read_b64_tr_b16 v[184:185], v19 offset:0
    ds_read_b64_tr_b16 v[186:187], v19 offset:1536
    s_add_u32 m0, s46, 112640
    s_nop 0
    buffer_load_dwordx4 v13, s[28:31], s42 offen lds
    s_mov_b32 s43, 0x3dd53b95
    s_waitcnt lgkmcnt(5)
    v_pk_add_f32 v[240:241], v[188:189], v[196:197]
    v_pk_add_f32 v[188:189], v[204:205], v[212:213]
    v_pk_add_f32 v[242:243], v[190:191], v[198:199]
    v_pk_add_f32 v[190:191], v[206:207], v[214:215]
    s_nop 1
    v_mfma_f32_16x16x32_bf16 v[60:63], v[92:95], v[140:143], 0
    v_pk_add_f32 v[244:245], v[192:193], v[200:201]
    v_pk_add_f32 v[192:193], v[208:209], v[216:217]
    s_nop 1
    v_mfma_f32_16x16x32_bf16 v[64:67], v[116:119], v[140:143], 0
    v_pk_add_f32 v[246:247], v[194:195], v[202:203]
    v_pk_add_f32 v[194:195], v[210:211], v[218:219]
    s_nop 1
    v_mfma_f32_16x16x32_bf16 v[68:71], v[92:95], v[144:147], 0
    v_pk_add_f32 v[240:241], v[240:241], v[188:189]
    v_pk_add_f32 v[242:243], v[242:243], v[190:191]
    s_nop 1
    v_mfma_f32_16x16x32_bf16 v[72:75], v[116:119], v[144:147], 0
    s_add_u32 m0, s46, 0
    s_mov_b32 s42, 24576
    buffer_load_dwordx4 v11, s[28:31], s42 offen lds
    v_pk_add_f32 v[244:245], v[244:245], v[192:193]
    v_pk_add_f32 v[246:247], v[246:247], v[194:195]
    s_nop 1
    v_mfma_f32_16x16x32_bf16 v[76:79], v[92:95], v[148:151], 0
    v_max3_f32 v48, v240, v241, v242
    v_max3_f32 v50, v244, v245, v246
    v_mfma_f32_16x16x32_bf16 v[80:83], v[116:119], v[148:151], 0
    v_max_f32 v48, v48, v243
    v_max_f32 v50, v50, v247
    v_mfma_f32_16x16x32_bf16 v[60:63], v[96:99], v[152:155], v[60:63]
    v_mov_b32 v49, v48
    v_mov_b32 v51, v50
    v_mfma_f32_16x16x32_bf16 v[64:67], v[120:123], v[152:155], v[64:67]
    s_add_u32 m0, s46, 1024
    s_nop 0
    buffer_load_dwordx4 v12, s[28:31], s42 offen lds
    v_permlane16_swap_b32 v48, v49
    v_permlane16_swap_b32 v50, v51
    v_mfma_f32_16x16x32_bf16 v[68:71], v[96:99], v[156:159], v[68:71]
    v_max_f32 v48, v48, v49
    v_max_f32 v50, v50, v51
    v_mfma_f32_16x16x32_bf16 v[72:75], v[120:123], v[156:159], v[72:75]
    v_mul_f32 v48, s43, v48
    v_mul_f32 v50, s43, v50
    v_mfma_f32_16x16x32_bf16 v[76:79], v[96:99], v[160:163], v[76:79]
    v_fma_f32 v240, v240, s43, -v48
    v_fma_f32 v244, v244, s43, -v50
    v_mfma_f32_16x16x32_bf16 v[80:83], v[120:123], v[160:163], v[80:83]
    s_add_u32 m0, s46, 2048
    s_nop 0
    buffer_load_dwordx4 v13, s[28:31], s42 offen lds
    v_fma_f32 v241, v241, s43, -v48
    v_fma_f32 v245, v245, s43, -v50
    v_mfma_f32_16x16x32_bf16 v[60:63], v[100:103], v[164:167], v[60:63]
    v_fma_f32 v242, v242, s43, -v48
    v_fma_f32 v246, v246, s43, -v50
    v_mfma_f32_16x16x32_bf16 v[64:67], v[124:127], v[164:167], v[64:67]
    v_fma_f32 v243, v243, s43, -v48
    v_fma_f32 v247, v247, s43, -v50
    v_mfma_f32_16x16x32_bf16 v[68:71], v[100:103], v[168:171], v[68:71]
    v_exp_f32 v240, v240
    v_exp_f32 v244, v244
    v_mfma_f32_16x16x32_bf16 v[72:75], v[124:127], v[168:171], v[72:75]
    s_add_u32 m0, s46, 12288
    s_mov_b32 s42, 36864
    buffer_load_dwordx4 v11, s[28:31], s42 offen lds
    v_exp_f32 v241, v241
    v_exp_f32 v245, v245
    v_mfma_f32_16x16x32_bf16 v[76:79], v[100:103], v[172:175], v[76:79]
    v_exp_f32 v242, v242
    v_exp_f32 v246, v246
    v_mfma_f32_16x16x32_bf16 v[80:83], v[124:127], v[172:175], v[80:83]
    v_exp_f32 v243, v243
    v_exp_f32 v247, v247
    s_waitcnt lgkmcnt(0)
    v_mfma_f32_16x16x32_bf16 v[60:63], v[104:107], v[176:179], v[60:63]
    v_add_f32 v48, v240, v241
    v_add_f32 v50, v244, v245
    v_mfma_f32_16x16x32_bf16 v[64:67], v[128:131], v[176:179], v[64:67]
    s_add_u32 m0, s46, 13312
    s_nop 0
    buffer_load_dwordx4 v12, s[28:31], s42 offen lds
    v_add_f32 v49, v242, v243
    v_add_f32 v51, v246, v247
    v_mfma_f32_16x16x32_bf16 v[68:71], v[104:107], v[180:183], v[68:71]
    v_add_f32 v48, v48, v49
    v_add_f32 v50, v50, v51
    v_mfma_f32_16x16x32_bf16 v[72:75], v[128:131], v[180:183], v[72:75]
    v_mov_b32 v49, v48
    v_mov_b32 v51, v50
    v_mfma_f32_16x16x32_bf16 v[76:79], v[104:107], v[184:187], v[76:79]
    v_permlane16_swap_b32 v48, v49
    v_permlane16_swap_b32 v50, v51
    v_mfma_f32_16x16x32_bf16 v[80:83], v[128:131], v[184:187], v[80:83]
    s_add_u32 m0, s46, 14336
    s_nop 0
    buffer_load_dwordx4 v13, s[28:31], s42 offen lds
    v_add_f32 v48, v48, v49
    v_add_f32 v50, v50, v51
    v_rcp_f32 v48, v48
    v_rcp_f32 v50, v50
    v_cndmask_b32 v48, 0, v48, s[44:45]
    v_cndmask_b32 v50, 0, v50, s[44:45]
    v_pk_mul_f32 v[240:241], v[240:241], v[48:49] op_sel_hi:[1,0]
    v_pk_mul_f32 v[244:245], v[244:245], v[50:51] op_sel_hi:[1,0]
    v_pk_mul_f32 v[242:243], v[242:243], v[48:49] op_sel_hi:[1,0]
    v_pk_mul_f32 v[246:247], v[246:247], v[50:51] op_sel_hi:[1,0]
    v_cvt_pk_bf16_f32 v236, v240, v241
    v_cvt_pk_bf16_f32 v238, v244, v245
    v_cvt_pk_bf16_f32 v237, v242, v243
    v_cvt_pk_bf16_f32 v239, v246, v247
    s_waitcnt vmcnt(12)
    s_barrier
    ds_read_b64_tr_b16 v[140:141], v17 offset:12288
    ds_read_b64_tr_b16 v[142:143], v17 offset:13824
    s_add_u32 m0, s46, 24576
    s_mov_b32 s42, 49152
    buffer_load_dwordx4 v11, s[28:31], s42 offen lds
    ds_read_b64_tr_b16 v[144:145], v18 offset:12288
    ds_read_b64_tr_b16 v[146:147], v18 offset:13824
    s_add_u32 m0, s46, 25600
    s_nop 0
    buffer_load_dwordx4 v12, s[28:31], s42 offen lds
    ds_read_b64_tr_b16 v[148:149], v19 offset:12288
    ds_read_b64_tr_b16 v[150:151], v19 offset:13824
    s_add_u32 m0, s46, 26624
    s_nop 0
    buffer_load_dwordx4 v13, s[28:31], s42 offen lds
    ds_read_b64_tr_b16 v[152:153], v17 offset:24576
    ds_read_b64_tr_b16 v[154:155], v17 offset:26112
    s_add_u32 m0, s46, 36864
    s_mov_b32 s42, 61440
    buffer_load_dwordx4 v11, s[28:31], s42 offen lds
    ds_read_b64_tr_b16 v[156:157], v18 offset:24576
    ds_read_b64_tr_b16 v[158:159], v18 offset:26112
    s_add_u32 m0, s46, 37888
    s_nop 0
    buffer_load_dwordx4 v12, s[28:31], s42 offen lds
    ds_read_b64_tr_b16 v[160:161], v19 offset:24576
    ds_read_b64_tr_b16 v[162:163], v19 offset:26112
    s_add_u32 m0, s46, 38912
    s_nop 0
    buffer_load_dwordx4 v13, s[28:31], s42 offen lds
    s_waitcnt lgkmcnt(4)
    v_mfma_f32_16x16x32_bf16 v[60:63], v[108:111], v[140:143], v[60:63]
    v_mfma_f32_16x16x32_bf16 v[64:67], v[132:135], v[140:143], v[64:67]
    v_mfma_f32_16x16x32_bf16 v[68:71], v[108:111], v[144:147], v[68:71]
    v_mfma_f32_16x16x32_bf16 v[72:75], v[132:135], v[144:147], v[72:75]
    v_mfma_f32_16x16x32_bf16 v[76:79], v[108:111], v[148:151], v[76:79]
    v_mfma_f32_16x16x32_bf16 v[80:83], v[132:135], v[148:151], v[80:83]
    v_mfma_f32_16x16x32_bf16 v[60:63], v[112:115], v[152:155], v[60:63]
    v_mfma_f32_16x16x32_bf16 v[64:67], v[136:139], v[152:155], v[64:67]
    s_waitcnt lgkmcnt(0)
    v_mfma_f32_16x16x32_bf16 v[68:71], v[112:115], v[156:159], v[68:71]
    v_mfma_f32_16x16x32_bf16 v[72:75], v[136:139], v[156:159], v[72:75]
    v_mfma_f32_16x16x32_bf16 v[76:79], v[112:115], v[160:163], v[76:79]
    v_mfma_f32_16x16x32_bf16 v[80:83], v[136:139], v[160:163], v[80:83]
    s_nop 1
    v_cvt_pk_bf16_f32 v48, v60, v61
    v_cvt_pk_bf16_f32 v49, v62, v63
    v_cvt_pk_bf16_f32 v50, v64, v65
    v_cvt_pk_bf16_f32 v51, v66, v67
    v_mfma_f32_16x16x16_bf16 v[188:191], v[48:49], v[236:237], 0
    v_cvt_pk_bf16_f32 v52, v68, v69
    v_cvt_pk_bf16_f32 v53, v70, v71
    v_mfma_f32_16x16x16_bf16 v[192:195], v[50:51], v[238:239], 0
    v_cvt_pk_bf16_f32 v54, v72, v73
    v_cvt_pk_bf16_f32 v55, v74, v75
    v_mfma_f32_16x16x16_bf16 v[196:199], v[52:53], v[236:237], 0
    v_cvt_pk_bf16_f32 v56, v76, v77
    v_cvt_pk_bf16_f32 v57, v78, v79
    v_mfma_f32_16x16x16_bf16 v[200:203], v[54:55], v[238:239], 0
    v_cvt_pk_bf16_f32 v58, v80, v81
    v_cvt_pk_bf16_f32 v59, v82, v83
    v_mfma_f32_16x16x16_bf16 v[204:207], v[56:57], v[236:237], 0
    s_nop 0
    v_mfma_f32_16x16x16_bf16 v[208:211], v[58:59], v[238:239], 0
    v_cvt_pk_bf16_f32 v48, v188, v189
    v_cvt_pk_bf16_f32 v49, v190, v191
    ds_write_b64 v20, v[48:49] offset:0
    v_cvt_pk_bf16_f32 v50, v192, v193
    v_cvt_pk_bf16_f32 v51, v194, v195
    ds_write_b64 v20, v[50:51] offset:6144
    v_cvt_pk_bf16_f32 v52, v196, v197
    v_cvt_pk_bf16_f32 v53, v198, v199
    ds_write_b64 v21, v[52:53] offset:0
    v_cvt_pk_bf16_f32 v54, v200, v201
    v_cvt_pk_bf16_f32 v55, v202, v203
    ds_write_b64 v21, v[54:55] offset:6144
    v_cvt_pk_bf16_f32 v56, v204, v205
    v_cvt_pk_bf16_f32 v57, v206, v207
    ds_write_b64 v22, v[56:57] offset:0
    v_cvt_pk_bf16_f32 v58, v208, v209
    v_cvt_pk_bf16_f32 v59, v210, v211
    ds_write_b64 v22, v[58:59] offset:6144
    s_waitcnt vmcnt(6)
    s_waitcnt lgkmcnt(0)
    s_barrier
    ds_read_b128 v[92:95], v23 offset:0
    ds_read_b128 v[116:119], v23 offset:6144
    ds_read_b128 v[96:99], v24 offset:0
    ds_read_b128 v[120:123], v24 offset:6144
    ds_read_b64_tr_b16 v[164:165], v17 offset:36864
    ds_read_b64_tr_b16 v[166:167], v17 offset:38400
    ds_read_b64_tr_b16 v[168:169], v18 offset:36864
    ds_read_b64_tr_b16 v[170:171], v18 offset:38400
    ds_read_b64_tr_b16 v[172:173], v19 offset:36864
    ds_read_b64_tr_b16 v[174:175], v19 offset:38400
    ds_read_b64_tr_b16 v[176:177], v17 offset:49152
    ds_read_b64_tr_b16 v[178:179], v17 offset:50688
    ds_read_b64_tr_b16 v[180:181], v18 offset:49152
    ds_read_b64_tr_b16 v[182:183], v18 offset:50688
    ds_read_b64_tr_b16 v[184:185], v19 offset:49152
    ds_read_b64_tr_b16 v[186:187], v19 offset:50688
    ds_read_b64_tr_b16 v[140:141], v14 offset:0
    ds_read_b64_tr_b16 v[142:143], v14 offset:1536
    ds_read_b64_tr_b16 v[144:145], v15 offset:0
    ds_read_b64_tr_b16 v[146:147], v15 offset:1536
    ds_read_b64_tr_b16 v[148:149], v16 offset:0
    ds_read_b64_tr_b16 v[150:151], v16 offset:1536
    ds_read_b64_tr_b16 v[152:153], v14 offset:12288
    ds_read_b64_tr_b16 v[154:155], v14 offset:13824
    ds_read_b64_tr_b16 v[156:157], v15 offset:12288
    ds_read_b64_tr_b16 v[158:159], v15 offset:13824
    ds_read_b64_tr_b16 v[160:161], v16 offset:12288
    ds_read_b64_tr_b16 v[162:163], v16 offset:13824
    ds_read_b128 v[100:103], v23 offset:128
    ds_read_b128 v[124:127], v23 offset:6272
    ds_read_b128 v[104:107], v24 offset:128
    ds_read_b128 v[128:131], v24 offset:6272
    ds_read_b128 v[108:111], v23 offset:256
    ds_read_b128 v[132:135], v23 offset:6400
    ds_read_b128 v[112:115], v24 offset:256
    ds_read_b128 v[136:139], v24 offset:6400
    s_waitcnt lgkmcnt(9)
    v_mfma_f32_16x16x32_bf16 v[212:215], v[164:167], v[92:95], 0
    v_mfma_f32_16x16x32_bf16 v[216:219], v[164:167], v[116:119], 0
    v_lshlrev_b32 v188, 16, v36
    v_and_b32 v189, s39, v36
    v_mfma_f32_16x16x32_bf16 v[220:223], v[168:171], v[92:95], 0
    v_mfma_f32_16x16x32_bf16 v[224:227], v[168:171], v[116:119], 0
    v_lshlrev_b32 v190, 16, v37
    v_and_b32 v191, s39, v37
    v_mfma_f32_16x16x32_bf16 v[228:231], v[172:175], v[92:95], 0
    v_mfma_f32_16x16x32_bf16 v[232:235], v[172:175], v[116:119], 0
    v_lshlrev_b32 v192, 16, v38
    v_and_b32 v193, s39, v38
    v_mfma_f32_16x16x32_bf16 v[212:215], v[176:179], v[96:99], v[212:215]
    v_mfma_f32_16x16x32_bf16 v[216:219], v[176:179], v[120:123], v[216:219]
    v_lshlrev_b32 v194, 16, v39
    v_and_b32 v195, s39, v39
    v_mfma_f32_16x16x32_bf16 v[220:223], v[180:183], v[96:99], v[220:223]
    v_mfma_f32_16x16x32_bf16 v[224:227], v[180:183], v[120:123], v[224:227]
    v_lshlrev_b32 v196, 16, v40
    v_and_b32 v197, s39, v40
    v_mfma_f32_16x16x32_bf16 v[228:231], v[184:187], v[96:99], v[228:231]
    v_mfma_f32_16x16x32_bf16 v[232:235], v[184:187], v[120:123], v[232:235]
    v_lshlrev_b32 v198, 16, v41
    v_and_b32 v199, s39, v41
    s_waitcnt lgkmcnt(0)
    v_mfma_f32_16x16x32_bf16 v[212:215], v[140:143], v[100:103], v[212:215]
    v_mfma_f32_16x16x32_bf16 v[216:219], v[140:143], v[124:127], v[216:219]
    v_lshlrev_b32 v200, 16, v42
    v_and_b32 v201, s39, v42
    v_mfma_f32_16x16x32_bf16 v[220:223], v[144:147], v[100:103], v[220:223]
    v_mfma_f32_16x16x32_bf16 v[224:227], v[144:147], v[124:127], v[224:227]
    v_lshlrev_b32 v202, 16, v43
    v_and_b32 v203, s39, v43
    v_mfma_f32_16x16x32_bf16 v[228:231], v[148:151], v[100:103], v[228:231]
    v_mfma_f32_16x16x32_bf16 v[232:235], v[148:151], v[124:127], v[232:235]
    v_lshlrev_b32 v204, 16, v44
    v_and_b32 v205, s39, v44
    v_mfma_f32_16x16x32_bf16 v[212:215], v[152:155], v[104:107], v[212:215]
    v_mfma_f32_16x16x32_bf16 v[216:219], v[152:155], v[128:131], v[216:219]
    v_lshlrev_b32 v206, 16, v45
    v_and_b32 v207, s39, v45
    v_mfma_f32_16x16x32_bf16 v[220:223], v[156:159], v[104:107], v[220:223]
    v_mfma_f32_16x16x32_bf16 v[224:227], v[156:159], v[128:131], v[224:227]
    v_lshlrev_b32 v208, 16, v46
    v_and_b32 v209, s39, v46
    v_mfma_f32_16x16x32_bf16 v[228:231], v[160:163], v[104:107], v[228:231]
    v_mfma_f32_16x16x32_bf16 v[232:235], v[160:163], v[128:131], v[232:235]
    v_lshlrev_b32 v210, 16, v47
    v_and_b32 v211, s39, v47
    s_waitcnt vmcnt(0)
    s_barrier
    ds_read_b64_tr_b16 v[164:165], v14 offset:24576
    ds_read_b64_tr_b16 v[166:167], v14 offset:26112
    ds_read_b64_tr_b16 v[168:169], v15 offset:24576
    ds_read_b64_tr_b16 v[170:171], v15 offset:26112
    ds_read_b64_tr_b16 v[172:173], v16 offset:24576
    ds_read_b64_tr_b16 v[174:175], v16 offset:26112
    ds_read_b64_tr_b16 v[176:177], v14 offset:36864
    ds_read_b64_tr_b16 v[178:179], v14 offset:38400
    ds_read_b64_tr_b16 v[180:181], v15 offset:36864
    ds_read_b64_tr_b16 v[182:183], v15 offset:38400
    ds_read_b64_tr_b16 v[184:185], v16 offset:36864
    ds_read_b64_tr_b16 v[186:187], v16 offset:38400
    s_waitcnt lgkmcnt(9)
    v_mfma_f32_16x16x32_bf16 v[212:215], v[164:167], v[108:111], v[212:215]
    v_mfma_f32_16x16x32_bf16 v[216:219], v[164:167], v[132:135], v[216:219]
    s_waitcnt lgkmcnt(6)
    v_mfma_f32_16x16x32_bf16 v[220:223], v[168:171], v[108:111], v[220:223]
    v_mfma_f32_16x16x32_bf16 v[224:227], v[168:171], v[132:135], v[224:227]
    v_mfma_f32_16x16x32_bf16 v[228:231], v[172:175], v[108:111], v[228:231]
    v_mfma_f32_16x16x32_bf16 v[232:235], v[172:175], v[132:135], v[232:235]
    s_waitcnt lgkmcnt(1)
    v_mfma_f32_16x16x32_bf16 v[212:215], v[176:179], v[112:115], v[212:215]
    v_mfma_f32_16x16x32_bf16 v[216:219], v[176:179], v[136:139], v[216:219]
    v_mfma_f32_16x16x32_bf16 v[220:223], v[180:183], v[112:115], v[220:223]
    v_mfma_f32_16x16x32_bf16 v[224:227], v[180:183], v[136:139], v[224:227]
    s_waitcnt lgkmcnt(0)
    v_mfma_f32_16x16x32_bf16 v[228:231], v[184:187], v[112:115], v[228:231]
    v_mfma_f32_16x16x32_bf16 v[232:235], v[184:187], v[136:139], v[232:235]
    s_nop 1
    v_cvt_pk_bf16_f32 v48, v212, v213
    v_cvt_pk_bf16_f32 v49, v214, v215
    ds_write_b64 v20, v[48:49] offset:12288
    v_cvt_pk_bf16_f32 v50, v216, v217
    v_cvt_pk_bf16_f32 v51, v218, v219
    ds_write_b64 v20, v[50:51] offset:18432
    v_cvt_pk_bf16_f32 v52, v220, v221
    v_cvt_pk_bf16_f32 v53, v222, v223
    ds_write_b64 v21, v[52:53] offset:12288
    v_cvt_pk_bf16_f32 v54, v224, v225
    v_cvt_pk_bf16_f32 v55, v226, v227
    ds_write_b64 v21, v[54:55] offset:18432
    v_cvt_pk_bf16_f32 v56, v228, v229
    v_cvt_pk_bf16_f32 v57, v230, v231
    ds_write_b64 v22, v[56:57] offset:12288
    v_cvt_pk_bf16_f32 v58, v232, v233
    v_cvt_pk_bf16_f32 v59, v234, v235
    ds_write_b64 v22, v[58:59] offset:18432
    s_waitcnt lgkmcnt(0)
    s_barrier
    ds_read_b128 v[36:39], v5 offset:12288
    ds_read_b128 v[40:43], v5 offset:12416
    ds_read_b128 v[44:47], v5 offset:12544
    s_waitcnt lgkmcnt(2)
    v_lshlrev_b32 v68, 16, v36
    v_and_b32 v69, s39, v36
    v_lshlrev_b32 v70, 16, v37
    v_and_b32 v71, s39, v37
    v_pk_add_f32 v[68:69], v[68:69], v[188:189]
    v_lshlrev_b32 v72, 16, v38
    v_and_b32 v73, s39, v38
    v_pk_add_f32 v[70:71], v[70:71], v[190:191]
    v_mov_b32 v60, v68
    v_mov_b32 v61, v69
    v_pk_mul_f32 v[62:63], v[68:69], v[68:69]
    v_lshlrev_b32 v74, 16, v39
    v_and_b32 v75, s39, v39
    v_pk_add_f32 v[72:73], v[72:73], v[192:193]
    v_pk_add_f32 v[60:61], v[60:61], v[70:71]
    v_pk_fma_f32 v[62:63], v[70:71], v[70:71], v[62:63]
    s_waitcnt lgkmcnt(0)
    v_lshlrev_b32 v76, 16, v40
    v_and_b32 v77, s39, v40
    v_pk_add_f32 v[74:75], v[74:75], v[194:195]
    v_pk_add_f32 v[60:61], v[60:61], v[72:73]
    v_pk_fma_f32 v[62:63], v[72:73], v[72:73], v[62:63]
    v_lshlrev_b32 v78, 16, v41
    v_and_b32 v79, s39, v41
    v_pk_add_f32 v[76:77], v[76:77], v[196:197]
    v_pk_add_f32 v[60:61], v[60:61], v[74:75]
    v_pk_fma_f32 v[62:63], v[74:75], v[74:75], v[62:63]
    v_lshlrev_b32 v80, 16, v42
    v_and_b32 v81, s39, v42
    v_pk_add_f32 v[78:79], v[78:79], v[198:199]
    v_pk_add_f32 v[60:61], v[60:61], v[76:77]
    v_pk_fma_f32 v[62:63], v[76:77], v[76:77], v[62:63]
    v_lshlrev_b32 v82, 16, v43
    v_and_b32 v83, s39, v43
    v_pk_add_f32 v[80:81], v[80:81], v[200:201]
    v_pk_add_f32 v[60:61], v[60:61], v[78:79]
    v_pk_fma_f32 v[62:63], v[78:79], v[78:79], v[62:63]
    v_lshlrev_b32 v84, 16, v44
    v_and_b32 v85, s39, v44
    v_pk_add_f32 v[82:83], v[82:83], v[202:203]
    v_pk_add_f32 v[60:61], v[60:61], v[80:81]
    v_pk_fma_f32 v[62:63], v[80:81], v[80:81], v[62:63]
    v_lshlrev_b32 v86, 16, v45
    v_and_b32 v87, s39, v45
    v_pk_add_f32 v[84:85], v[84:85], v[204:205]
    v_pk_add_f32 v[60:61], v[60:61], v[82:83]
    v_pk_fma_f32 v[62:63], v[82:83], v[82:83], v[62:63]
    v_lshlrev_b32 v88, 16, v46
    v_and_b32 v89, s39, v46
    v_pk_add_f32 v[86:87], v[86:87], v[206:207]
    v_pk_add_f32 v[60:61], v[60:61], v[84:85]
    v_pk_fma_f32 v[62:63], v[84:85], v[84:85], v[62:63]
    v_lshlrev_b32 v90, 16, v47
    v_and_b32 v91, s39, v47
    v_pk_add_f32 v[88:89], v[88:89], v[208:209]
    v_pk_add_f32 v[60:61], v[60:61], v[86:87]
    v_pk_fma_f32 v[62:63], v[86:87], v[86:87], v[62:63]
    v_pk_add_f32 v[90:91], v[90:91], v[210:211]
    v_pk_add_f32 v[60:61], v[60:61], v[88:89]
    v_pk_fma_f32 v[62:63], v[88:89], v[88:89], v[62:63]
    v_pk_add_f32 v[60:61], v[60:61], v[90:91]
    v_pk_fma_f32 v[62:63], v[90:91], v[90:91], v[62:63]
    v_add_f32 v60, v60, v61
    v_add_f32 v62, v62, v63
    s_nop 0
    v_add_f32_dpp v60, v60, v60 quad_perm:[1,0,3,2] row_mask:0xf bank_mask:0xf
    v_add_f32_dpp v62, v62, v62 quad_perm:[1,0,3,2] row_mask:0xf bank_mask:0xf
    s_nop 0
    v_add_f32_dpp v60, v60, v60 quad_perm:[2,3,0,1] row_mask:0xf bank_mask:0xf
    v_add_f32_dpp v62, v62, v62 quad_perm:[2,3,0,1] row_mask:0xf bank_mask:0xf
    s_nop 0
    v_add_f32_dpp v60, v60, v60 row_half_mirror row_mask:0xf bank_mask:0xf
    v_add_f32_dpp v62, v62, v62 row_half_mirror row_mask:0xf bank_mask:0xf
    v_mul_f32 v64, 0x3baaaaab, v60
    v_mul_f32 v62, 0x3baaaaab, v62
    v_fma_f32 v62, -v64, v64, v62
    v_max_f32 v62, 0, v62
    v_add_f32 v62, 0x3727c5ac, v62
    v_rsq_f32 v66, v62
    s_nop 0
    v_mul_f32 v67, v64, v66
    v_mul_f32 v65, v62, v66
    v_pk_fma_f32 v[68:69], v[68:69], v[66:67], v[66:67] op_sel:[0,0,1] op_sel_hi:[1,0,1] neg_lo:[0,0,1] neg_hi:[0,0,1]
    v_pk_fma_f32 v[70:71], v[70:71], v[66:67], v[66:67] op_sel:[0,0,1] op_sel_hi:[1,0,1] neg_lo:[0,0,1] neg_hi:[0,0,1]
    v_pk_fma_f32 v[72:73], v[72:73], v[66:67], v[66:67] op_sel:[0,0,1] op_sel_hi:[1,0,1] neg_lo:[0,0,1] neg_hi:[0,0,1]
    v_cvt_pk_bf16_f32 v92, v68, v69
    v_pk_fma_f32 v[74:75], v[74:75], v[66:67], v[66:67] op_sel:[0,0,1] op_sel_hi:[1,0,1] neg_lo:[0,0,1] neg_hi:[0,0,1]
    v_cvt_pk_bf16_f32 v93, v70, v71
    v_pk_fma_f32 v[76:77], v[76:77], v[66:67], v[66:67] op_sel:[0,0,1] op_sel_hi:[1,0,1] neg_lo:[0,0,1] neg_hi:[0,0,1]
    v_cvt_pk_bf16_f32 v94, v72, v73
    v_pk_fma_f32 v[78:79], v[78:79], v[66:67], v[66:67] op_sel:[0,0,1] op_sel_hi:[1,0,1] neg_lo:[0,0,1] neg_hi:[0,0,1]
    v_cvt_pk_bf16_f32 v95, v74, v75
    buffer_store_dwordx4 v[92:95], v6, s[32:35], 0 offen sc1
    buffer_store_dwordx2 v[64:65], v7, s[32:35], 0 offen sc1
    v_pk_fma_f32 v[80:81], v[80:81], v[66:67], v[66:67] op_sel:[0,0,1] op_sel_hi:[1,0,1] neg_lo:[0,0,1] neg_hi:[0,0,1]
    v_cvt_pk_bf16_f32 v96, v76, v77
    v_pk_fma_f32 v[82:83], v[82:83], v[66:67], v[66:67] op_sel:[0,0,1] op_sel_hi:[1,0,1] neg_lo:[0,0,1] neg_hi:[0,0,1]
    v_cvt_pk_bf16_f32 v97, v78, v79
    v_pk_fma_f32 v[84:85], v[84:85], v[66:67], v[66:67] op_sel:[0,0,1] op_sel_hi:[1,0,1] neg_lo:[0,0,1] neg_hi:[0,0,1]
    v_cvt_pk_bf16_f32 v98, v80, v81
    v_pk_fma_f32 v[86:87], v[86:87], v[66:67], v[66:67] op_sel:[0,0,1] op_sel_hi:[1,0,1] neg_lo:[0,0,1] neg_hi:[0,0,1]
    v_cvt_pk_bf16_f32 v99, v82, v83
    buffer_store_dwordx4 v[96:99], v6, s[32:35], 0 offen offset:128 sc1
    v_pk_fma_f32 v[88:89], v[88:89], v[66:67], v[66:67] op_sel:[0,0,1] op_sel_hi:[1,0,1] neg_lo:[0,0,1] neg_hi:[0,0,1]
    v_cvt_pk_bf16_f32 v100, v84, v85
    v_pk_fma_f32 v[90:91], v[90:91], v[66:67], v[66:67] op_sel:[0,0,1] op_sel_hi:[1,0,1] neg_lo:[0,0,1] neg_hi:[0,0,1]
    v_cvt_pk_bf16_f32 v101, v86, v87
    v_cvt_pk_bf16_f32 v102, v88, v89
    v_cvt_pk_bf16_f32 v103, v90, v91
    buffer_store_dwordx4 v[100:103], v6, s[32:35], 0 offen offset:256 sc1
    s_endpgm
K1_side:
    s_waitcnt lgkmcnt(0)
    s_mov_b32 s20, s10
    s_and_b32 s21, s11, 0xffff
    s_mov_b32 s22, 0x36000
    s_mov_b32 s23, 0x20000
    s_mov_b32 s24, s12
    s_and_b32 s25, s13, 0xffff
    s_mov_b32 s26, 0x12000
    s_mov_b32 s27, 0x20000
    s_mov_b32 s32, s18
    s_and_b32 s33, s19, 0xffff
    s_mov_b32 s34, 0x469800
    s_mov_b32 s35, 0x20000
    s_sub_u32 s3, s2, 183
    s_mov_b32 s52, s6
    s_and_b32 s53, s7, 0xffff
    s_mov_b32 s54, 0x36000
    s_mov_b32 s55, 0x20000
    s_mov_b32 s56, s8
    s_and_b32 s57, s9, 0xffff
    s_mov_b32 s58, 0x12000
    s_mov_b32 s59, 0x20000
    s_cmp_ge_u32 s3, 32
    s_cbranch_scc1 AK1_spf_2
    s_lshr_b32 s40, s3, 3
    s_lshl_b32 s40, s40, 2
    s_add_u32 s40, s40, s36
    s_mul_i32 s40, s40, 7
    s_add_u32 s40, s40, 184
    v_lshlrev_b32 v4, 4, v1
    s_cmp_lt_u32 s40, 216
    s_cselect_b32 s60, s52, s56
    s_cselect_b32 s61, s53, s57
    s_cselect_b32 s62, s54, s58
    s_cselect_b32 s63, s55, s59
    s_cselect_b32 s41, 0, 216
    s_sub_u32 s41, s40, s41
    s_lshl_b32 s41, s41, 10
    buffer_load_dwordx4 v[160:163], v4, s[60:63], s41 offen
    s_add_u32 s40, s40, 1
    s_cmp_lt_u32 s40, 216
    s_cselect_b32 s60, s52, s56
    s_cselect_b32 s61, s53, s57
    s_cselect_b32 s62, s54, s58
    s_cselect_b32 s63, s55, s59
    s_cselect_b32 s41, 0, 216
    s_sub_u32 s41, s40, s41
    s_lshl_b32 s41, s41, 10
    buffer_load_dwordx4 v[164:167], v4, s[60:63], s41 offen
    s_add_u32 s40, s40, 1
    s_cmp_lt_u32 s40, 216
    s_cselect_b32 s60, s52, s56
    s_cselect_b32 s61, s53, s57
    s_cselect_b32 s62, s54, s58
    s_cselect_b32 s63, s55, s59
    s_cselect_b32 s41, 0, 216
    s_sub_u32 s41, s40, s41
    s_lshl_b32 s41, s41, 10
    buffer_load_dwordx4 v[168:171], v4, s[60:63], s41 offen
    s_add_u32 s40, s40, 1
    s_cmp_lt_u32 s40, 216
    s_cselect_b32 s60, s52, s56
    s_cselect_b32 s61, s53, s57
    s_cselect_b32 s62, s54, s58
    s_cselect_b32 s63, s55, s59
    s_cselect_b32 s41, 0, 216
    s_sub_u32 s41, s40, s41
    s_lshl_b32 s41, s41, 10
    buffer_load_dwordx4 v[172:175], v4, s[60:63], s41 offen
    s_add_u32 s40, s40, 1
    s_cmp_lt_u32 s40, 216
    s_cselect_b32 s60, s52, s56
    s_cselect_b32 s61, s53, s57
    s_cselect_b32 s62, s54, s58
    s_cselect_b32 s63, s55, s59
    s_cselect_b32 s41, 0, 216
    s_sub_u32 s41, s40, s41
    s_lshl_b32 s41, s41, 10
    buffer_load_dwordx4 v[176:179], v4, s[60:63], s41 offen
    s_add_u32 s40, s40, 1
    s_cmp_lt_u32 s40, 216
    s_cselect_b32 s60, s52, s56
    s_cselect_b32 s61, s53, s57
    s_cselect_b32 s62, s54, s58
    s_cselect_b32 s63, s55, s59
    s_cselect_b32 s41, 0, 216
    s_sub_u32 s41, s40, s41
    s_lshl_b32 s41, s41, 10
    buffer_load_dwordx4 v[180:183], v4, s[60:63], s41 offen
    s_add_u32 s40, s40, 1
    s_cmp_lt_u32 s40, 216
    s_cselect_b32 s60, s52, s56
    s_cselect_b32 s61, s53, s57
    s_cselect_b32 s62, s54, s58
    s_cselect_b32 s63, s55, s59
    s_cselect_b32 s41, 0, 216
    s_sub_u32 s41, s40, s41
    s_lshl_b32 s41, s41, 10
    buffer_load_dwordx4 v[184:187], v4, s[60:63], s41 offen
    s_add_u32 s40, s40, 1
AK1_spf_2:
    s_sub_u32 s40, s2, 183
    s_lshl_b32 s40, s40, 2
    s_add_u32 s40, s40, s36
    s_cmp_ge_u32 s40, 72
    s_cselect_b32 s47, 1, 0
    s_cselect_b32 s41, 72, 0
    s_sub_u32 s40, s40, s41
    s_mul_i32 s48, s40, 43
    s_lshr_b32 s48, s48, 8
    s_mul_i32 s41, s48, 6
    s_sub_u32 s49, s40, s41
    s_mul_i32 s51, s48, 43
    s_lshr_b32 s51, s51, 7
    s_mul_i32 s41, s51, 3
    s_sub_u32 s52, s48, s41
    s_mul_i32 s50, s51, 18
    s_mul_i32 s41, s49, 3
    s_add_u32 s50, s50, s41
    s_add_u32 s50, s50, s52
    s_lshl_b32 s50, s50, 10
    v_lshlrev_b32 v10, 4, v1
    v_add_u32 v10, s50, v10
    s_cmp_eq_u32 s47, 1
    s_cbranch_scc1 K1_side_w
    v_lshrrev_b32 v4, 2, v2
    v_and_b32 v5, 3, v2
    v_lshl_add_u32 v4, v4, 3, v5
    s_lshl_b32 s41, s49, 5
    v_add_u32 v4, s41, v4
    v_mul_u32_u24 v4, 1152, v4
    v_lshl_add_u32 v8, v3, 4, v4
    v_lshrrev_b32 v5, 2, v2
    v_and_b32 v7, 3, v2
    v_lshl_add_u32 v5, v5, 3, v7
    s_lshl_b32 s41, s52, 2
    v_add_u32 v5, s41, v5
    v_add_u32 v7, 32, v2
    s_cmp_eq_u32 s52, 2
    s_cselect_b64 vcc, -1, 0
    v_cndmask_b32 v5, v5, v7, vcc
    s_mul_i32 s41, s51, 48
    v_add_u32 v5, s41, v5
    v_mul_u32_u24 v5, 1152, v5
    v_lshl_add_u32 v9, v3, 4, v5
    v_add_u32 v6, 4608, v8
    buffer_load_dwordx4 v[16:19], v8, s[20:23], 0 offen offset:0
    buffer_load_dwordx4 v[40:43], v6, s[20:23], 0 offen offset:0
    buffer_load_dwordx4 v[64:67], v9, s[20:23], 0 offen offset:384
    buffer_load_dwordx4 v[20:23], v8, s[20:23], 0 offen offset:64
    buffer_load_dwordx4 v[44:47], v6, s[20:23], 0 offen offset:64
    buffer_load_dwordx4 v[68:71], v9, s[20:23], 0 offen offset:448
    buffer_load_dwordx4 v[24:27], v8, s[20:23], 0 offen offset:128
    buffer_load_dwordx4 v[48:51], v6, s[20:23], 0 offen offset:128
    buffer_load_dwordx4 v[72:75], v9, s[20:23], 0 offen offset:512
    buffer_load_dwordx4 v[28:31], v8, s[20:23], 0 offen offset:192
    buffer_load_dwordx4 v[52:55], v6, s[20:23], 0 offen offset:192
    buffer_load_dwordx4 v[76:79], v9, s[20:23], 0 offen offset:576
    buffer_load_dwordx4 v[32:35], v8, s[20:23], 0 offen offset:256
    buffer_load_dwordx4 v[56:59], v6, s[20:23], 0 offen offset:256
    buffer_load_dwordx4 v[80:83], v9, s[20:23], 0 offen offset:640
    buffer_load_dwordx4 v[36:39], v8, s[20:23], 0 offen offset:320
    buffer_load_dwordx4 v[60:63], v6, s[20:23], 0 offen offset:320
    buffer_load_dwordx4 v[84:87], v9, s[20:23], 0 offen offset:704
    s_waitcnt vmcnt(15)
    v_mfma_f32_16x16x32_bf16 v[112:115], v[16:19], v[64:67], 0
    v_mfma_f32_16x16x32_bf16 v[116:119], v[40:43], v[64:67], 0
    s_waitcnt vmcnt(12)
    v_mfma_f32_16x16x32_bf16 v[112:115], v[20:23], v[68:71], v[112:115]
    v_mfma_f32_16x16x32_bf16 v[116:119], v[44:47], v[68:71], v[116:119]
    s_waitcnt vmcnt(9)
    v_mfma_f32_16x16x32_bf16 v[112:115], v[24:27], v[72:75], v[112:115]
    v_mfma_f32_16x16x32_bf16 v[116:119], v[48:51], v[72:75], v[116:119]
    s_waitcnt vmcnt(6)
    v_mfma_f32_16x16x32_bf16 v[112:115], v[28:31], v[76:79], v[112:115]
    v_mfma_f32_16x16x32_bf16 v[116:119], v[52:55], v[76:79], v[116:119]
    s_waitcnt vmcnt(3)
    v_mfma_f32_16x16x32_bf16 v[112:115], v[32:35], v[80:83], v[112:115]
    v_mfma_f32_16x16x32_bf16 v[116:119], v[56:59], v[80:83], v[116:119]
    s_waitcnt vmcnt(0)
    v_mfma_f32_16x16x32_bf16 v[112:115], v[36:39], v[84:87], v[112:115]
    v_mfma_f32_16x16x32_bf16 v[116:119], v[60:63], v[84:87], v[116:119]
    s_mov_b32 s41, 0x3dd53b95
    s_nop 5
    v_mul_f32 v112, s41, v112
    v_mul_f32 v113, s41, v113
    v_mul_f32 v114, s41, v114
    v_mul_f32 v115, s41, v115
    v_mul_f32 v116, s41, v116
    v_mul_f32 v117, s41, v117
    v_mul_f32 v118, s41, v118
    v_mul_f32 v119, s41, v119
    v_cvt_pk_bf16_f32 v120, v112, v113
    v_cvt_pk_bf16_f32 v121, v114, v115
    v_cvt_pk_bf16_f32 v122, v116, v117
    v_cvt_pk_bf16_f32 v123, v118, v119
    v_add_u32 v10, 4478976, v10
    buffer_store_dwordx4 v[120:123], v10, s[32:35], 0 offen sc1
    s_endpgm
K1_side_w:
    v_lshrrev_b32 v4, 3, v2
    v_bfe_u32 v5, v2, 2, 1
    v_lshlrev_b32 v4, 4, v4
    v_lshl_add_u32 v4, v5, 2, v4
    v_and_b32 v5, 3, v2
    v_add_u32 v4, v4, v5
    s_lshl_b32 s41, s49, 5
    v_add_u32 v4, s41, v4
    v_mul_u32_u24 v4, 1152, v4
    v_lshl_add_u32 v8, v3, 4, v4
    v_add_u32 v6, 9216, v8
    s_mul_i32 s51, s51, 48
    v_lshrrev_b32 v4, 2, v2
    v_and_b32 v5, 3, v2
    v_lshl_add_u32 v4, v4, 3, v5
    s_lshl_b32 s41, s52, 2
    v_add_u32 v4, s41, v4
    v_add_u32 v5, 32, v2
    s_cmp_eq_u32 s52, 2
    s_cselect_b64 vcc, -1, 0
    v_cndmask_b32 v4, v4, v5, vcc
    v_add_u32 v4, s51, v4
    v_lshlrev_b32 v4, 1, v4
    v_mul_u32_u24 v5, 3072, v3
    v_add_u32 v9, v4, v5
    buffer_load_dwordx4 v[16:19], v8, s[20:23], 0 offen offset:768
    buffer_load_dwordx4 v[40:43], v6, s[20:23], 0 offen offset:768
    buffer_load_dwordx4 v[20:23], v8, s[20:23], 0 offen offset:832
    buffer_load_dwordx4 v[44:47], v6, s[20:23], 0 offen offset:832
    buffer_load_dwordx4 v[24:27], v8, s[20:23], 0 offen offset:896
    buffer_load_dwordx4 v[48:51], v6, s[20:23], 0 offen offset:896
    buffer_load_dwordx4 v[28:31], v8, s[20:23], 0 offen offset:960
    buffer_load_dwordx4 v[52:55], v6, s[20:23], 0 offen offset:960
    buffer_load_dwordx4 v[32:35], v8, s[20:23], 0 offen offset:1024
    buffer_load_dwordx4 v[56:59], v6, s[20:23], 0 offen offset:1024
    buffer_load_dwordx4 v[36:39], v8, s[20:23], 0 offen offset:1088
    buffer_load_dwordx4 v[60:63], v6, s[20:23], 0 offen offset:1088
    s_mov_b32 s41, 0
    buffer_load_ushort v64, v9, s[24:27], s41 offen offset:0
    buffer_load_ushort v65, v9, s[24:27], s41 offen offset:384
    buffer_load_ushort v66, v9, s[24:27], s41 offen offset:768
    buffer_load_ushort v67, v9, s[24:27], s41 offen offset:1152
    buffer_load_ushort v68, v9, s[24:27], s41 offen offset:1536
    buffer_load_ushort v69, v9, s[24:27], s41 offen offset:1920
    buffer_load_ushort v70, v9, s[24:27], s41 offen offset:2304
    buffer_load_ushort v71, v9, s[24:27], s41 offen offset:2688
    s_mov_b32 s41, 12288
    buffer_load_ushort v72, v9, s[24:27], s41 offen offset:0
    buffer_load_ushort v73, v9, s[24:27], s41 offen offset:384
    buffer_load_ushort v74, v9, s[24:27], s41 offen offset:768
    buffer_load_ushort v75, v9, s[24:27], s41 offen offset:1152
    buffer_load_ushort v76, v9, s[24:27], s41 offen offset:1536
    buffer_load_ushort v77, v9, s[24:27], s41 offen offset:1920
    buffer_load_ushort v78, v9, s[24:27], s41 offen offset:2304
    buffer_load_ushort v79, v9, s[24:27], s41 offen offset:2688
    s_mov_b32 s41, 24576
    buffer_load_ushort v80, v9, s[24:27], s41 offen offset:0
    buffer_load_ushort v81, v9, s[24:27], s41 offen offset:384
    buffer_load_ushort v82, v9, s[24:27], s41 offen offset:768
    buffer_load_ushort v83, v9, s[24:27], s41 offen offset:1152
    buffer_load_ushort v84, v9, s[24:27], s41 offen offset:1536
    buffer_load_ushort v85, v9, s[24:27], s41 offen offset:1920
    buffer_load_ushort v86, v9, s[24:27], s41 offen offset:2304
    buffer_load_ushort v87, v9, s[24:27], s41 offen offset:2688
    s_mov_b32 s41, 36864
    buffer_load_ushort v88, v9, s[24:27], s41 offen offset:0
    buffer_load_ushort v89, v9, s[24:27], s41 offen offset:384
    buffer_load_ushort v90, v9, s[24:27], s41 offen offset:768
    buffer_load_ushort v91, v9, s[24:27], s41 offen offset:1152
    buffer_load_ushort v92, v9, s[24:27], s41 offen offset:1536
    buffer_load_ushort v93, v9, s[24:27], s41 offen offset:1920
    buffer_load_ushort v94, v9, s[24:27], s41 offen offset:2304
    buffer_load_ushort v95, v9, s[24:27], s41 offen offset:2688
    s_mov_b32 s41, 49152
    buffer_load_ushort v96, v9, s[24:27], s41 offen offset:0
    buffer_load_ushort v97, v9, s[24:27], s41 offen offset:384
    buffer_load_ushort v98, v9, s[24:27], s41 offen offset:768
    buffer_load_ushort v99, v9, s[24:27], s41 offen offset:1152
    buffer_load_ushort v100, v9, s[24:27], s41 offen offset:1536
    buffer_load_ushort v101, v9, s[24:27], s41 offen offset:1920
    buffer_load_ushort v102, v9, s[24:27], s41 offen offset:2304
    buffer_load_ushort v103, v9, s[24:27], s41 offen offset:2688
    s_mov_b32 s41, 61440
    buffer_load_ushort v104, v9, s[24:27], s41 offen offset:0
    buffer_load_ushort v105, v9, s[24:27], s41 offen offset:384
    buffer_load_ushort v106, v9, s[24:27], s41 offen offset:768
    buffer_load_ushort v107, v9, s[24:27], s41 offen offset:1152
    buffer_load_ushort v108, v9, s[24:27], s41 offen offset:1536
    buffer_load_ushort v109, v9, s[24:27], s41 offen offset:1920
    buffer_load_ushort v110, v9, s[24:27], s41 offen offset:2304
    buffer_load_ushort v111, v9, s[24:27], s41 offen offset:2688
    s_waitcnt vmcnt(46)
    v_lshl_or_b32 v128, v65, 16, v64
    s_waitcnt vmcnt(44)
    v_lshl_or_b32 v129, v67, 16, v66
    s_waitcnt vmcnt(42)
    v_lshl_or_b32 v130, v69, 16, v68
    s_waitcnt vmcnt(40)
    v_lshl_or_b32 v131, v71, 16, v70
    s_waitcnt vmcnt(38)
    v_lshl_or_b32 v132, v73, 16, v72
    s_waitcnt vmcnt(36)
    v_lshl_or_b32 v133, v75, 16, v74
    s_waitcnt vmcnt(34)
    v_lshl_or_b32 v134, v77, 16, v76
    s_waitcnt vmcnt(32)
    v_lshl_or_b32 v135, v79, 16, v78
    s_waitcnt vmcnt(30)
    v_lshl_or_b32 v136, v81, 16, v80
    s_waitcnt vmcnt(28)
    v_lshl_or_b32 v137, v83, 16, v82
    s_waitcnt vmcnt(26)
    v_lshl_or_b32 v138, v85, 16, v84
    s_waitcnt vmcnt(24)
    v_lshl_or_b32 v139, v87, 16, v86
    s_waitcnt vmcnt(22)
    v_lshl_or_b32 v140, v89, 16, v88
    s_waitcnt vmcnt(20)
    v_lshl_or_b32 v141, v91, 16, v90
    s_waitcnt vmcnt(18)
    v_lshl_or_b32 v142, v93, 16, v92
    s_waitcnt vmcnt(16)
    v_lshl_or_b32 v143, v95, 16, v94
    s_waitcnt vmcnt(14)
    v_lshl_or_b32 v144, v97, 16, v96
    s_waitcnt vmcnt(12)
    v_lshl_or_b32 v145, v99, 16, v98
    s_waitcnt vmcnt(10)
    v_lshl_or_b32 v146, v101, 16, v100
    s_waitcnt vmcnt(8)
    v_lshl_or_b32 v147, v103, 16, v102
    s_waitcnt vmcnt(6)
    v_lshl_or_b32 v148, v105, 16, v104
    s_waitcnt vmcnt(4)
    v_lshl_or_b32 v149, v107, 16, v106
    s_waitcnt vmcnt(2)
    v_lshl_or_b32 v150, v109, 16, v108
    s_waitcnt vmcnt(0)
    v_lshl_or_b32 v151, v111, 16, v110
    v_mfma_f32_16x16x32_bf16 v[112:115], v[16:19], v[128:131], 0
    v_mfma_f32_16x16x32_bf16 v[116:119], v[40:43], v[128:131], 0
    v_mfma_f32_16x16x32_bf16 v[112:115], v[20:23], v[132:135], v[112:115]
    v_mfma_f32_16x16x32_bf16 v[116:119], v[44:47], v[132:135], v[116:119]
    v_mfma_f32_16x16x32_bf16 v[112:115], v[24:27], v[136:139], v[112:115]
    v_mfma_f32_16x16x32_bf16 v[116:119], v[48:51], v[136:139], v[116:119]
    v_mfma_f32_16x16x32_bf16 v[112:115], v[28:31], v[140:143], v[112:115]
    v_mfma_f32_16x16x32_bf16 v[116:119], v[52:55], v[140:143], v[116:119]
    v_mfma_f32_16x16x32_bf16 v[112:115], v[32:35], v[144:147], v[112:115]
    v_mfma_f32_16x16x32_bf16 v[116:119], v[56:59], v[144:147], v[116:119]
    v_mfma_f32_16x16x32_bf16 v[112:115], v[36:39], v[148:151], v[112:115]
    v_mfma_f32_16x16x32_bf16 v[116:119], v[60:63], v[148:151], v[116:119]
    s_nop 6
    v_cvt_pk_bf16_f32 v120, v112, v113
    v_cvt_pk_bf16_f32 v121, v114, v115
    v_cvt_pk_bf16_f32 v122, v116, v117
    v_cvt_pk_bf16_f32 v123, v118, v119
    v_add_u32 v10, 4552704, v10
    buffer_store_dwordx4 v[120:123], v10, s[32:35], 0 offen sc1
K1_done:
    s_endpgm
.text
.globl tsf_spatial_kernel
.p2align 8
.type tsf_spatial_kernel,@function
tsf_spatial_kernel:
    s_cmp_ge_u32 s2, 184
    s_cbranch_scc1 K2_done
    s_load_dwordx16 s[4:19], s[0:1], 0
    v_and_b32 v1, 63, v0
    v_lshrrev_b32 v44, 6, v0
    s_and_b32 s38, s2, 7
    v_readfirstlane_b32 s36, v44
    s_lshr_b32 s37, s2, 3
    s_mul_i32 s40, s38, 279936
    v_lshlrev_b32 v12, 4, v1
    s_mul_i32 s60, s37, 12288
    s_mul_i32 s61, s37, 7
    s_mul_i32 s41, s36, 18432
    v_add_u32 v37, s41, v12
    s_mul_i32 s41, s36, 3072
    v_add_u32 v49, s41, v12
    s_add_u32 s61, s61, s36
    s_waitcnt lgkmcnt(0)
    s_add_u32 s32, s18, 4478976
    s_addc_u32 s33, s19, 0
    s_and_b32 s33, s33, 0xffff
    s_mov_b32 s34, 147456
    s_mov_b32 s35, 0x20000
    s_lshl_b32 s42, s61, 10
    buffer_load_dwordx4 v[220:223], v12, s[32:35], s42 offen
    s_add_u32 s42, s42, 4096
    s_cmp_eq_u32 s36, 3
    s_cselect_b32 s42, 1048576, s42
    buffer_load_dwordx4 v[224:227], v12, s[32:35], s42 offen
    s_lshl_b32 s42, s37, 2
    s_add_u32 s42, s42, s36
    s_getpc_b64 s[62:63]
BL_pc_1:
    s_sub_u32 s62, s62, BL_pc_1-tsf_spatial_kernel
    s_subb_u32 s63, s63, 0
    s_lshl_b32 s42, s42, 10
    v_add_u32 v44, s42, v12
    v_min_u32 v44, TEXT_end-tsf_spatial_kernel-16, v44
    v_mov_b32 v45, s63
    v_add_co_u32 v44, vcc, s62, v44
    s_nop 1
    v_addc_co_u32 v45, vcc, 0, v45, vcc
    global_load_dwordx4 v[252:255], v[44:45], off
    s_add_u32 s20, s18, s40
    s_addc_u32 s21, s19, 0
    s_and_b32 s21, s21, 0xffff
    s_mov_b32 s22, 0x44580
    s_mov_b32 s23, 0x20000
    s_mul_i32 m0, s36, 3072
    s_nop 0
    buffer_load_dwordx4 v49, s[20:23], s60 offen offset:0 lds
    buffer_load_dwordx4 v49, s[20:23], s60 offen offset:1024 lds
    buffer_load_dwordx4 v49, s[20:23], s60 offen offset:2048 lds
    s_mov_b32 s43, 0
    buffer_load_dwordx4 a[96:99], v37, s[32:35], s43 offen offset:0
    buffer_load_dwordx4 a[100:103], v37, s[32:35], s43 offen offset:1024
    buffer_load_dwordx4 a[104:107], v37, s[32:35], s43 offen offset:2048
    buffer_load_dwordx4 a[108:111], v37, s[32:35], s43 offen offset:3072
    s_mov_b32 s43, 4096
    buffer_load_dwordx4 a[112:115], v37, s[32:35], s43 offen offset:0
    buffer_load_dwordx4 a[116:119], v37, s[32:35], s43 offen offset:1024
    buffer_load_dwordx4 a[120:123], v37, s[32:35], s43 offen offset:2048
    buffer_load_dwordx4 a[124:127], v37, s[32:35], s43 offen offset:3072
    v_and_b32 v2, 15, v0
    v_bfe_u32 v3, v0, 4, 2
    s_mul_i32 s50, s36, 36864
    s_add_u32 s41, s36, 0
    s_add_u32 s42, s41, s37
    s_cmp_ge_u32 s42, 23
    s_cselect_b32 s43, 23, 0
    s_sub_u32 s42, s42, s43
    s_mul_i32 s44, s42, 12288
    s_add_u32 s41, s36, 4
    s_add_u32 s42, s41, s37
    s_cmp_ge_u32 s42, 23
    s_cselect_b32 s43, 23, 0
    s_sub_u32 s42, s42, s43
    s_mul_i32 s45, s42, 12288
    s_add_u32 s41, s36, 8
    s_add_u32 s42, s41, s37
    s_cmp_ge_u32 s42, 23
    s_cselect_b32 s43, 23, 0
    s_sub_u32 s42, s42, s43
    s_mul_i32 s46, s42, 12288
    s_add_u32 s41, s36, 12
    s_add_u32 s42, s41, s37
    s_cmp_ge_u32 s42, 23
    s_cselect_b32 s43, 23, 0
    s_sub_u32 s42, s42, s43
    s_mul_i32 s47, s42, 12288
    s_add_u32 s41, s36, 16
    s_add_u32 s42, s41, s37
    s_cmp_ge_u32 s42, 23
    s_cselect_b32 s43, 23, 0
    s_sub_u32 s42, s42, s43
    s_mul_i32 s48, s42, 12288
    s_add_u32 s41, s36, 20
    s_add_u32 s42, s41, s37
    s_cmp_ge_u32 s42, 23
    s_cselect_b32 s43, 23, 0
    s_sub_u32 s42, s42, s43
    s_mul_i32 s49, s42, 12288
    s_cmp_ge_u32 s41, 23
    s_cselect_b32 s49, 1048576, s49
    s_mov_b32 s54, 0
    s_mov_b32 s67, 6144
    s_mov_b32 s55, 0xffff0000
    s_cmp_eq_u32 s36, 0
    s_cselect_b32 s65, s45, s44
    s_cselect_b32 s66, s46, s45
    s_cselect_b32 s64, 12288, 0
    s_add_u32 s64, s64, s50
    v_add_u32 v13, 4096, v12
    v_add_u32 v14, 8192, v12
    s_mov_b32 s42, 0
    s_add_u32 s24, s18, s42
    s_addc_u32 s25, s19, 0
    s_add_u32 s24, s24, 2239488
    s_addc_u32 s25, s25, 0
    s_and_b32 s25, s25, 0xffff
    s_mov_b32 s26, 0xb700
    s_mov_b32 s27, 0x20000
    s_add_u32 s28, s14, s40
    s_addc_u32 s29, s15, 0
    s_and_b32 s29, s29, 0xffff
    s_mov_b32 s30, 0x44580
    s_mov_b32 s31, 0x20000
    v_and_b32 v44, 31, v1
    v_lshrrev_b32 v45, 5, v1
    v_bfe_u32 v46, v44, 1, 1
    v_bfe_u32 v47, v44, 2, 2
    v_lshl_or_b32 v46, v46, 2, v47
    v_xor_b32 v46, v46, v45
    v_mul_u32_u24 v47, 384, v44
    v_add_u32 v47, s50, v47
    v_xor_b32 v48, 0, v46
    v_lshl_add_u32 v4, v48, 4, v47
    v_xor_b32 v48, 2, v46
    v_lshl_add_u32 v5, v48, 4, v47
    v_xor_b32 v48, 4, v46
    v_lshl_add_u32 v6, v48, 4, v47
    v_xor_b32 v48, 6, v46
    v_lshl_add_u32 v7, v48, 4, v47
    v_and_b32 v46, 7, v44
    v_bfe_u32 v48, v44, 3, 1
    v_xor_b32 v46, v46, v48
    v_xor_b32 v46, v46, v45
    v_xor_b32 v48, 0, v46
    v_lshl_add_u32 v21, v48, 4, v47
    v_xor_b32 v48, 2, v46
    v_lshl_add_u32 v22, v48, 4, v47
    v_xor_b32 v48, 4, v46
    v_lshl_add_u32 v23, v48, 4, v47
    v_xor_b32 v48, 6, v46
    v_lshl_add_u32 v24, v48, 4, v47
    v_lshlrev_b32 v38, 4, v44
    s_lshl_b32 s41, s36, 2
    s_add_u32 s41, s41, 159744
    v_add_u32 v38, s41, v38
    v_cmp_lt_u32 s[52:53], 31, v1
    v_lshrrev_b32 v44, 1, v3
    v_and_b32 v45, 1, v3
    v_lshrrev_b32 v46, 2, v2
    v_bfe_u32 v47, v0, 1, 1
    v_lshl_or_b32 v47, v45, 1, v47
    v_lshrrev_b32 v48, 1, v46
    v_lshl_or_b32 v48, v48, 2, v44
    v_xor_b32 v47, v47, v48
    v_lshl_add_u32 v44, v44, 2, v46
    v_mul_u32_u24 v44, 384, v44
    v_and_b32 v45, 1, v0
    v_lshl_add_u32 v44, v45, 3, v44
    v_add_u32 v44, s50, v44
    v_xor_b32 v48, 0, v47
    v_lshl_add_u32 v48, v48, 4, v44
    v_add_u32 v8, 0, v48
    v_xor_b32 v48, 2, v47
    v_lshl_add_u32 v48, v48, 4, v44
    v_add_u32 v9, 3072, v48
    v_xor_b32 v48, 4, v47
    v_lshl_add_u32 v48, v48, 4, v44
    v_add_u32 v10, 0, v48
    v_xor_b32 v48, 6, v47
    v_lshl_add_u32 v48, v48, 4, v44
    v_add_u32 v11, 3072, v48
    v_bfe_u32 v44, v2, 1, 1
    v_lshrrev_b32 v45, 2, v2
    v_lshl_or_b32 v44, v44, 2, v45
    v_mul_u32_u24 v45, 384, v2
    v_add_u32 v48, 0, v3
    v_xor_b32 v48, v48, v44
    v_lshl_add_u32 v16, v48, 4, v45
    v_add_u32 v48, 4, v3
    v_xor_b32 v48, v48, v44
    v_lshl_add_u32 v17, v48, 4, v45
    s_mul_i32 s41, s36, 6
    v_lshrrev_b32 v46, 1, v3
    v_and_b32 v47, 1, v3
    v_lshl_add_u32 v49, v47, 3, v45
    v_add_u32 v49, 147456, v49
    v_add_u32 v48, s41, v3
    v_xor_b32 v48, v48, v44
    v_lshl_add_u32 v18, v48, 4, v45
    v_add_u32 v18, 147456, v18
    s_add_u32 s42, s41, 4
    v_add_u32 v48, s42, v46
    v_xor_b32 v48, v48, v44
    v_lshl_add_u32 v19, v48, 4, v49
    v_lshrrev_b32 v44, 1, v2
    s_add_u32 s42, s41, 0
    v_add_u32 v48, s42, v46
    v_xor_b32 v48, v48, v44
    v_lshl_add_u32 v28, v48, 4, v49
    s_add_u32 s42, s41, 2
    v_add_u32 v48, s42, v46
    v_xor_b32 v48, v48, v44
    v_lshl_add_u32 v29, v48, 4, v49
    s_add_u32 s42, s41, 4
    v_add_u32 v48, s42, v46
    v_xor_b32 v48, v48, v44
    v_lshl_add_u32 v30, v48, 4, v49
    v_add_u32 v48, 0, v3
    v_xor_b32 v48, v48, v44
    v_lshl_add_u32 v48, v48, 4, v45
    v_add_u32 v31, 147456, v48
    v_add_u32 v48, 4, v3
    v_xor_b32 v48, v48, v44
    v_lshl_add_u32 v48, v48, 4, v45
    v_add_u32 v32, 147456, v48
    v_and_b32 v44, 7, v2
    v_lshrrev_b32 v48, 3, v2
    v_xor_b32 v44, v44, v48
    v_mul_u32_u24 v47, 36864, v47
    v_add_u32 v47, v47, v45
    s_add_u32 s42, s41, 0
    v_add_u32 v48, s42, v46
    v_xor_b32 v48, v48, v44
    v_lshl_add_u32 v25, v48, 4, v47
    s_add_u32 s42, s41, 2
    v_add_u32 v48, s42, v46
    v_xor_b32 v48, v48, v44
    v_lshl_add_u32 v26, v48, 4, v47
    s_add_u32 s42, s41, 4
    v_add_u32 v48, s42, v46
    v_xor_b32 v48, v48, v44
    v_lshl_add_u32 v27, v48, 4, v47
    v_lshlrev_b32 v39, 4, v2
    v_add_u32 v39, 159744, v39
    s_lshl_b32 s42, s37, 5
    v_add_u32 v44, s42, v2
    v_lshrrev_b32 v45, 2, v44
    v_lshlrev_b32 v45, 8, v45
    v_and_b32 v46, 3, v44
    v_lshl_add_u32 v45, v46, 3, v45
    s_lshl_b32 s42, s38, 5
    v_add_u32 v15, s42, v45
    v_mul_u32_u24 v44, 384, v44
    v_and_b32 v46, 7, v2
    v_mul_u32_u24 v45, 384, v2
    s_mul_i32 s42, s36, 6
    v_add_u32 v47, s42, v3
    v_xor_b32 v47, v47, v46
    v_lshl_add_u32 v33, v47, 4, v45
    v_lshrrev_b32 v47, 1, v3
    s_add_u32 s42, s42, 4
    v_add_u32 v47, s42, v47
    v_xor_b32 v47, v47, v46
    v_lshl_add_u32 v47, v47, 4, v45
    v_and_b32 v46, 1, v3
    v_lshl_add_u32 v34, v46, 3, v47
    v_lshrrev_b32 v45, 3, v1
    v_and_b32 v46, 7, v1
    s_lshl_b32 s42, s36, 3
    v_add_u32 v47, s42, v45
    v_mul_u32_u24 v47, 384, v47
    v_xor_b32 v45, v45, v46
    v_lshl_add_u32 v35, v45, 4, v47
    v_lshl_add_u32 v47, v46, 4, v47
    v_add_u32 v36, s60, v47
    v_bfe_u32 v46, v2, 1, 1
    v_lshrrev_b32 v47, 2, v2
    v_lshl_or_b32 v46, v46, 2, v47
    s_mul_i32 s42, s36, 6
    v_add_u32 v47, s42, v3
    v_xor_b32 v47, v47, v46
    v_lshl_add_u32 v50, v47, 4, v44
    v_lshrrev_b32 v47, 1, v3
    s_add_u32 s42, s42, 4
    v_add_u32 v47, s42, v47
    v_xor_b32 v47, v47, v46
    v_lshl_add_u32 v47, v47, 4, v44
    v_and_b32 v46, 1, v3
    v_lshl_add_u32 v51, v46, 3, v47
    v_lshrrev_b32 v44, 1, v3
    v_lshlrev_b32 v44, 3, v44
    v_sub_u32 v44, v2, v44
    v_mov_b32 v45, 0x3f80
    v_mov_b32 v46, 0x3f800000
    v_cmp_eq_u32 vcc, 0, v44
    s_nop 1
    v_cndmask_b32 v47, 0, v45, vcc
    v_cmp_eq_u32 vcc, 1, v44
    s_nop 1
    v_cndmask_b32 v48, 0, v46, vcc
    v_or_b32 v52, v47, v48
    v_cmp_eq_u32 vcc, 2, v44
    s_nop 1
    v_cndmask_b32 v47, 0, v45, vcc
    v_cmp_eq_u32 vcc, 3, v44
    s_nop 1
    v_cndmask_b32 v48, 0, v46, vcc
    v_or_b32 v53, v47, v48
    v_cmp_eq_u32 vcc, 4, v44
    s_nop 1
    v_cndmask_b32 v47, 0, v45, vcc
    v_cmp_eq_u32 vcc, 5, v44
    s_nop 1
    v_cndmask_b32 v48, 0, v46, vcc
    v_or_b32 v54, v47, v48
    v_cmp_eq_u32 vcc, 6, v44
    s_nop 1
    v_cndmask_b32 v47, 0, v45, vcc
    v_cmp_eq_u32 vcc, 7, v44
    s_nop 1
    v_cndmask_b32 v48, 0, v46, vcc
    v_or_b32 v55, v47, v48
    v_mov_b32 v40, 0
    v_mov_b32 v41, 0
    v_mov_b32 v42, 0
    v_mov_b32 v43, 0
    s_mov_b32 s43, 8192
    buffer_load_dwordx4 a[128:131], v37, s[32:35], s43 offen offset:0
    buffer_load_dwordx4 a[132:135], v37, s[32:35], s43 offen offset:1024
    buffer_load_dwordx4 a[136:139], v37, s[32:35], s43 offen offset:2048
    buffer_load_dwordx4 a[140:143], v37, s[32:35], s43 offen offset:3072
    s_mov_b32 s43, 12288
    buffer_load_dwordx4 a[144:147], v37, s[32:35], s43 offen offset:0
    buffer_load_dwordx4 a[148:151], v37, s[32:35], s43 offen offset:1024
    buffer_load_dwordx4 a[152:155], v37, s[32:35], s43 offen offset:2048
    buffer_load_dwordx4 a[156:159], v37, s[32:35], s43 offen offset:3072
    s_mov_b32 s43, 16384
    buffer_load_dwordx4 a[160:163], v37, s[32:35], s43 offen offset:0
    buffer_load_dwordx4 a[164:167], v37, s[32:35], s43 offen offset:1024
    s_waitcnt vmcnt(18)
    s_barrier
    ds_read_b128 v[104:107], v16 offset:0
    ds_read_b128 v[128:131], v16 offset:6144
    ds_read_b128 v[108:111], v17 offset:0
    ds_read_b128 v[132:135], v17 offset:6144
    ds_read_b128 v[112:115], v16 offset:128
    ds_read_b128 v[136:139], v16 offset:6272
    ds_read_b128 v[116:119], v17 offset:128
    ds_read_b128 v[140:143], v17 offset:6272
    ds_read_b128 v[120:123], v16 offset:256
    ds_read_b128 v[144:147], v16 offset:6400
    ds_read_b128 v[124:127], v17 offset:256
    ds_read_b128 v[148:151], v17 offset:6400
    s_waitcnt vmcnt(17) lgkmcnt(9)
    v_mfma_f32_16x16x32_bf16 v[72:75], a[96:99], v[104:107], 0
    v_mfma_f32_16x16x32_bf16 v[76:79], a[96:99], v[128:131], 0
    s_add_u32 m0, s64, 0
    s_nop 0
    buffer_load_dwordx4 v12, s[20:23], s65 offen offset:0 lds
    s_waitcnt vmcnt(17)
    v_mfma_f32_16x16x32_bf16 v[80:83], a[100:103], v[104:107], 0
    v_mfma_f32_16x16x32_bf16 v[84:87], a[100:103], v[128:131], 0
    s_waitcnt vmcnt(16)
    v_mfma_f32_16x16x32_bf16 v[88:91], a[104:107], v[104:107], 0
    v_mfma_f32_16x16x32_bf16 v[92:95], a[104:107], v[128:131], 0
    buffer_load_dwordx4 v12, s[20:23], s65 offen offset:1024 lds
    s_waitcnt vmcnt(16)
    v_mfma_f32_16x16x32_bf16 v[72:75], a[108:111], v[108:111], v[72:75]
    s_waitcnt lgkmcnt(0)
    v_mfma_f32_16x16x32_bf16 v[76:79], a[108:111], v[132:135], v[76:79]
    buffer_load_dwordx4 v12, s[20:23], s65 offen offset:2048 lds
    s_waitcnt vmcnt(16)
    v_mfma_f32_16x16x32_bf16 v[80:83], a[112:115], v[108:111], v[80:83]
    v_mfma_f32_16x16x32_bf16 v[84:87], a[112:115], v[132:135], v[84:87]
    s_waitcnt vmcnt(15)
    v_mfma_f32_16x16x32_bf16 v[88:91], a[116:119], v[108:111], v[88:91]
    v_mfma_f32_16x16x32_bf16 v[92:95], a[116:119], v[132:135], v[92:95]
    buffer_load_dwordx4 v12, s[20:23], s65 offen offset:3072 lds
    s_waitcnt vmcnt(15)
    v_mfma_f32_16x16x32_bf16 v[72:75], a[120:123], v[112:115], v[72:75]
    v_mfma_f32_16x16x32_bf16 v[76:79], a[120:123], v[136:139], v[76:79]
    s_add_u32 m0, s64, 4096
    s_nop 0
    buffer_load_dwordx4 v13, s[20:23], s65 offen offset:0 lds
    s_waitcnt vmcnt(15)
    v_mfma_f32_16x16x32_bf16 v[80:83], a[124:127], v[112:115], v[80:83]
    v_mfma_f32_16x16x32_bf16 v[84:87], a[124:127], v[136:139], v[84:87]
    s_waitcnt vmcnt(14)
    v_mfma_f32_16x16x32_bf16 v[88:91], a[128:131], v[112:115], v[88:91]
    v_mfma_f32_16x16x32_bf16 v[92:95], a[128:131], v[136:139], v[92:95]
    buffer_load_dwordx4 v13, s[20:23], s65 offen offset:1024 lds
    s_waitcnt vmcnt(14)
    v_mfma_f32_16x16x32_bf16 v[72:75], a[132:135], v[116:119], v[72:75]
    v_mfma_f32_16x16x32_bf16 v[76:79], a[132:135], v[140:143], v[76:79]
    buffer_load_dwordx4 v13, s[20:23], s65 offen offset:2048 lds
    s_waitcnt vmcnt(14)
    v_mfma_f32_16x16x32_bf16 v[80:83], a[136:139], v[116:119], v[80:83]
    v_mfma_f32_16x16x32_bf16 v[84:87], a[136:139], v[140:143], v[84:87]
    s_waitcnt vmcnt(13)
    v_mfma_f32_16x16x32_bf16 v[88:91], a[140:143], v[116:119], v[88:91]
    v_mfma_f32_16x16x32_bf16 v[92:95], a[140:143], v[140:143], v[92:95]
    buffer_load_dwordx4 v13, s[20:23], s65 offen offset:3072 lds
    s_waitcnt vmcnt(13)
    v_mfma_f32_16x16x32_bf16 v[72:75], a[144:147], v[120:123], v[72:75]
    v_mfma_f32_16x16x32_bf16 v[76:79], a[144:147], v[144:147], v[76:79]
    s_add_u32 m0, s64, 8192
    s_nop 0
    buffer_load_dwordx4 v14, s[20:23], s65 offen offset:0 lds
    s_waitcnt vmcnt(13)
    v_mfma_f32_16x16x32_bf16 v[80:83], a[148:151], v[120:123], v[80:83]
    v_mfma_f32_16x16x32_bf16 v[84:87], a[148:151], v[144:147], v[84:87]
    s_waitcnt vmcnt(12)
    v_mfma_f32_16x16x32_bf16 v[88:91], a[152:155], v[120:123], v[88:91]
    v_mfma_f32_16x16x32_bf16 v[92:95], a[152:155], v[144:147], v[92:95]
    buffer_load_dwordx4 v14, s[20:23], s65 offen offset:1024 lds
    s_waitcnt vmcnt(12)
    v_mfma_f32_16x16x32_bf16 v[72:75], a[156:159], v[124:127], v[72:75]
    v_mfma_f32_16x16x32_bf16 v[76:79], a[156:159], v[148:151], v[76:79]
    buffer_load_dwordx4 v14, s[20:23], s65 offen offset:2048 lds
    s_waitcnt vmcnt(12)
    v_mfma_f32_16x16x32_bf16 v[80:83], a[160:163], v[124:127], v[80:83]
    v_mfma_f32_16x16x32_bf16 v[84:87], a[160:163], v[148:151], v[84:87]
    s_waitcnt vmcnt(11)
    v_mfma_f32_16x16x32_bf16 v[88:91], a[164:167], v[124:127], v[88:91]
    v_mfma_f32_16x16x32_bf16 v[92:95], a[164:167], v[148:151], v[92:95]
    buffer_load_dwordx4 v14, s[20:23], s65 offen offset:3072 lds
    v_cvt_pk_bf16_f32 v56, v72, v73
    v_cvt_pk_bf16_f32 v57, v74, v75
    s_nop 0
    v_cvt_pk_bf16_f32 v58, v80, v81
    v_cvt_pk_bf16_f32 v59, v82, v83
    s_nop 0
    v_cvt_pk_bf16_f32 v60, v88, v89
    v_cvt_pk_bf16_f32 v61, v90, v91
    ds_write_b128 v18, v[56:59] offset:0
    ds_write_b64 v19, v[60:61] offset:0
    v_cvt_pk_bf16_f32 v62, v76, v77
    v_cvt_pk_bf16_f32 v63, v78, v79
    v_cvt_pk_bf16_f32 v64, v84, v85
    v_cvt_pk_bf16_f32 v65, v86, v87
    v_cvt_pk_bf16_f32 v66, v92, v93
    v_cvt_pk_bf16_f32 v67, v94, v95
    ds_write_b128 v18, v[62:65] offset:6144
    ds_write_b64 v19, v[66:67] offset:6144
    v_subrev_u32 v44, s50, v4
    v_add_u32 v44, 147456, v44
    v_subrev_u32 v45, s50, v5
    v_add_u32 v45, 147456, v45
    v_subrev_u32 v46, s50, v6
    v_add_u32 v46, 147456, v46
    v_subrev_u32 v47, s50, v7
    v_add_u32 v47, 147456, v47
    s_add_u32 m0, s64, 12288
    s_nop 0
    buffer_load_dwordx4 v12, s[20:23], s66 offen offset:0 lds
    buffer_load_dwordx4 v12, s[20:23], s66 offen offset:1024 lds
    buffer_load_dwordx4 v12, s[20:23], s66 offen offset:2048 lds
    s_waitcnt lgkmcnt(0)
    s_barrier
    ds_read_b128 a[0:3], v44 offset:0
    ds_read_b128 a[4:7], v45 offset:0
    ds_read_b128 a[8:11], v46 offset:0
    buffer_load_dwordx4 v12, s[20:23], s66 offen offset:3072 lds
    ds_read_b128 a[12:15], v47 offset:0
    ds_read_b128 a[16:19], v44 offset:128
    ds_read_b128 a[20:23], v45 offset:128
    s_add_u32 m0, s64, 16384
    s_nop 0
    buffer_load_dwordx4 v13, s[20:23], s66 offen offset:0 lds
    ds_read_b128 a[24:27], v46 offset:128
    ds_read_b128 a[28:31], v47 offset:128
    ds_read_b128 a[32:35], v44 offset:256
    buffer_load_dwordx4 v13, s[20:23], s66 offen offset:1024 lds
    ds_read_b128 a[36:39], v45 offset:256
    ds_read_b128 a[40:43], v46 offset:256
    ds_read_b128 a[44:47], v47 offset:256
    buffer_load_dwordx4 v13, s[20:23], s66 offen offset:2048 lds
    v_add_u32 v16, 73728, v25
    v_add_u32 v17, 73728, v26
    v_add_u32 v18, 73728, v27
    s_waitcnt vmcnt(7)
    ds_read_b128 a[48:51], v4 offset:0
    ds_read_b128 a[52:55], v5 offset:0
    ds_read_b128 a[56:59], v6 offset:0
    buffer_load_dwordx4 v13, s[20:23], s66 offen offset:3072 lds
    ds_read_b128 a[60:63], v7 offset:0
    ds_read_b128 a[64:67], v4 offset:128
    ds_read_b128 a[68:71], v5 offset:128
    s_add_u32 m0, s64, 20480
    s_nop 0
    buffer_load_dwordx4 v14, s[20:23], s66 offen offset:0 lds
    ds_read_b128 a[72:75], v6 offset:128
    ds_read_b128 a[76:79], v7 offset:128
    ds_read_b128 a[80:83], v4 offset:256
    buffer_load_dwordx4 v14, s[20:23], s66 offen offset:1024 lds
    ds_read_b128 a[84:87], v5 offset:256
    ds_read_b128 a[88:91], v6 offset:256
    ds_read_b128 a[92:95], v7 offset:256
    buffer_load_dwordx4 v14, s[20:23], s66 offen offset:2048 lds
    buffer_load_dwordx4 v14, s[20:23], s66 offen offset:3072 lds
    s_waitcnt lgkmcnt(6)
    v_mfma_f32_32x32x16_bf16 v[72:87], a[48:51], a[0:3], 0
    ds_read_b64_tr_b16 a[96:97], v8 offset:0
    ds_read_b64_tr_b16 a[98:99], v9 offset:0
    v_mfma_f32_32x32x16_bf16 v[72:87], a[52:55], a[4:7], v[72:87]
    ds_read_b64_tr_b16 a[100:101], v10 offset:0
    ds_read_b64_tr_b16 a[102:103], v11 offset:0
    v_mfma_f32_32x32x16_bf16 v[72:87], a[56:59], a[8:11], v[72:87]
    ds_read_b64_tr_b16 a[104:105], v8 offset:128
    ds_read_b64_tr_b16 a[106:107], v9 offset:128
    v_mfma_f32_32x32x16_bf16 v[72:87], a[60:63], a[12:15], v[72:87]
    ds_read_b64_tr_b16 a[108:109], v10 offset:128
    ds_read_b64_tr_b16 a[110:111], v11 offset:128
    s_cmp_eq_u32 s36, 0
    s_cbranch_scc1 BK2_c_2
    s_add_u32 m0, s50, 24576
    s_nop 0
    buffer_load_dwordx4 v12, s[20:23], s46 offen offset:0 lds
    buffer_load_dwordx4 v12, s[20:23], s46 offen offset:1024 lds
    buffer_load_dwordx4 v12, s[20:23], s46 offen offset:2048 lds
BK2_c_2:
    v_mfma_f32_32x32x16_bf16 v[72:87], a[64:67], a[16:19], v[72:87]
    ds_read_b64_tr_b16 a[112:113], v8 offset:256
    ds_read_b64_tr_b16 a[114:115], v9 offset:256
    v_mfma_f32_32x32x16_bf16 v[72:87], a[68:71], a[20:23], v[72:87]
    ds_read_b64_tr_b16 a[116:117], v10 offset:256
    ds_read_b64_tr_b16 a[118:119], v11 offset:256
    s_waitcnt lgkmcnt(4)
    v_mfma_f32_32x32x16_bf16 v[72:87], a[72:75], a[24:27], v[72:87]
    ds_read_b64_tr_b16 a[120:121], v8 offset:6144
    ds_read_b64_tr_b16 a[122:123], v9 offset:6144
    v_mfma_f32_32x32x16_bf16 v[72:87], a[76:79], a[28:31], v[72:87]
    ds_read_b64_tr_b16 a[124:125], v10 offset:6144
    ds_read_b64_tr_b16 a[126:127], v11 offset:6144
    v_mfma_f32_32x32x16_bf16 v[72:87], a[80:83], a[32:35], v[72:87]
    ds_read_b64_tr_b16 a[128:129], v8 offset:6272
    ds_read_b64_tr_b16 a[130:131], v9 offset:6272
    s_cmp_eq_u32 s36, 0
    s_cbranch_scc1 BK2_c_3
    buffer_load_dwordx4 v12, s[20:23], s46 offen offset:3072 lds
    s_add_u32 m0, s50, 28672
    s_nop 0
    buffer_load_dwordx4 v13, s[20:23], s46 offen offset:0 lds
    buffer_load_dwordx4 v13, s[20:23], s46 offen offset:1024 lds
BK2_c_3:
    v_mfma_f32_32x32x16_bf16 v[72:87], a[84:87], a[36:39], v[72:87]
    ds_read_b64_tr_b16 a[132:133], v10 offset:6272
    ds_read_b64_tr_b16 a[134:135], v11 offset:6272
    v_mfma_f32_32x32x16_bf16 v[72:87], a[88:91], a[40:43], v[72:87]
    ds_read_b64_tr_b16 a[136:137], v8 offset:6400
    ds_read_b64_tr_b16 a[138:139], v9 offset:6400
    v_mfma_f32_32x32x16_bf16 v[72:87], a[92:95], a[44:47], v[72:87]
    ds_read_b64_tr_b16 a[140:141], v10 offset:6400
    ds_read_b64_tr_b16 a[142:143], v11 offset:6400
    s_waitcnt vmcnt(6)
    ds_read_b128 a[48:51], v4 offset:12288
    ds_read_b128 a[52:55], v5 offset:12288
    ds_read_b128 a[56:59], v6 offset:12288
    ds_read_b128 a[60:63], v7 offset:12288
    ds_read_b128 a[64:67], v4 offset:12416
    ds_read_b128 a[68:71], v5 offset:12416
    ds_read_b128 a[72:75], v6 offset:12416
    ds_read_b128 a[76:79], v7 offset:12416
    ds_read_b128 a[80:83], v4 offset:12544
    ds_read_b128 a[84:87], v5 offset:12544
    ds_read_b128 a[88:91], v6 offset:12544
    ds_read_b128 a[92:95], v7 offset:12544
    s_waitcnt lgkmcnt(8)
    v_mfma_f32_32x32x16_bf16 v[88:103], a[48:51], a[0:3], 0
    ds_read_b64_tr_b16 a[144:145], v8 offset:12288
    ds_read_b64_tr_b16 a[146:147], v9 offset:12288
    v_exp_f32 v72, v72
    v_exp_f32 v73, v73
    v_mfma_f32_32x32x16_bf16 v[88:103], a[52:55], a[4:7], v[88:103]
    ds_read_b64_tr_b16 a[148:149], v10 offset:12288
    ds_read_b64_tr_b16 a[150:151], v11 offset:12288
    v_exp_f32 v74, v74
    v_exp_f32 v75, v75
    s_cmp_eq_u32 s36, 0
    s_cbranch_scc1 BK2_c_4
    buffer_load_dwordx4 v13, s[20:23], s46 offen offset:2048 lds
    buffer_load_dwordx4 v13, s[20:23], s46 offen offset:3072 lds
    s_add_u32 m0, s50, 32768
    s_nop 0
    buffer_load_dwordx4 v14, s[20:23], s46 offen offset:0 lds
BK2_c_4:
    v_mfma_f32_32x32x16_bf16 v[88:103], a[56:59], a[8:11], v[88:103]
    ds_read_b64_tr_b16 a[152:153], v8 offset:12416
    ds_read_b64_tr_b16 a[154:155], v9 offset:12416
    v_exp_f32 v76, v76
    v_exp_f32 v77, v77
    v_mfma_f32_32x32x16_bf16 v[88:103], a[60:63], a[12:15], v[88:103]
    ds_read_b64_tr_b16 a[156:157], v10 offset:12416
    ds_read_b64_tr_b16 a[158:159], v11 offset:12416
    v_exp_f32 v78, v78
    v_exp_f32 v79, v79
    s_waitcnt lgkmcnt(4)
    v_mfma_f32_32x32x16_bf16 v[88:103], a[64:67], a[16:19], v[88:103]
    ds_read_b64_tr_b16 a[160:161], v8 offset:12544
    ds_read_b64_tr_b16 a[162:163], v9 offset:12544
    v_add_f32 v40, v40, v72
    v_add_f32 v41, v41, v73
    v_cvt_pk_bf16_f32 v56, v72, v73
    v_mfma_f32_32x32x16_bf16 v[88:103], a[68:71], a[20:23], v[88:103]
    ds_read_b64_tr_b16 a[164:165], v10 offset:12544
    ds_read_b64_tr_b16 a[166:167], v11 offset:12544
    v_add_f32 v40, v40, v74
    v_add_f32 v41, v41, v75
    v_cvt_pk_bf16_f32 v57, v74, v75
    s_cmp_eq_u32 s36, 0
    s_cbranch_scc1 BK2_c_5
    buffer_load_dwordx4 v14, s[20:23], s46 offen offset:1024 lds
    buffer_load_dwordx4 v14, s[20:23], s46 offen offset:2048 lds
    buffer_load_dwordx4 v14, s[20:23], s46 offen offset:3072 lds
BK2_c_5:
    v_mfma_f32_32x32x16_bf16 v[88:103], a[72:75], a[24:27], v[88:103]
    ds_read_b64_tr_b16 a[168:169], v8 offset:18432
    ds_read_b64_tr_b16 a[170:171], v9 offset:18432
    v_add_f32 v40, v40, v76
    v_add_f32 v41, v41, v77
    v_cvt_pk_bf16_f32 v58, v76, v77
    v_mfma_f32_32x32x16_bf16 v[88:103], a[76:79], a[28:31], v[88:103]
    ds_read_b64_tr_b16 a[172:173], v10 offset:18432
    ds_read_b64_tr_b16 a[174:175], v11 offset:18432
    v_add_f32 v40, v40, v78
    v_add_f32 v41, v41, v79
    v_cvt_pk_bf16_f32 v59, v78, v79
    v_mfma_f32_32x32x16_bf16 v[88:103], a[80:83], a[32:35], v[88:103]
    ds_read_b64_tr_b16 a[176:177], v8 offset:18560
    ds_read_b64_tr_b16 a[178:179], v9 offset:18560
    v_exp_f32 v80, v80
    v_exp_f32 v81, v81
    v_mfma_f32_32x32x16_bf16 v[88:103], a[84:87], a[36:39], v[88:103]
    ds_read_b64_tr_b16 a[180:181], v10 offset:18560
    ds_read_b64_tr_b16 a[182:183], v11 offset:18560
    v_exp_f32 v82, v82
    v_exp_f32 v83, v83
    v_mfma_f32_32x32x16_bf16 v[88:103], a[88:91], a[40:43], v[88:103]
    ds_read_b64_tr_b16 a[184:185], v8 offset:18688
    ds_read_b64_tr_b16 a[186:187], v9 offset:18688
    v_exp_f32 v84, v84
    v_exp_f32 v85, v85
    v_mfma_f32_32x32x16_bf16 v[88:103], a[92:95], a[44:47], v[88:103]
    ds_read_b64_tr_b16 a[188:189], v10 offset:18688
    ds_read_b64_tr_b16 a[190:191], v11 offset:18688
    v_exp_f32 v86, v86
    v_exp_f32 v87, v87
    v_mfma_f32_32x32x16_bf16 v[104:119], a[96:99], v[56:59], 0
    s_cmp_eq_u32 s44, 270336
    s_cbranch_scc0 BK2_msk_6
    v_mov_b32 v48, 0
    v_cndmask_b32 v84, v84, v48, s[52:53]
    v_mov_b32 v85, 0
    v_mov_b32 v86, 0
    v_mov_b32 v87, 0
BK2_msk_6:
    v_add_f32 v40, v40, v80
    v_add_f32 v41, v41, v81
    s_add_u32 m0, s50, 0
    s_nop 0
    buffer_load_dwordx4 v12, s[20:23], s47 offen offset:0 lds
    v_mfma_f32_32x32x16_bf16 v[120:135], a[100:103], v[56:59], 0
    v_cvt_pk_bf16_f32 v60, v80, v81
    v_add_f32 v40, v40, v82
    v_add_f32 v41, v41, v83
    buffer_load_dwordx4 v12, s[20:23], s47 offen offset:1024 lds
    v_mfma_f32_32x32x16_bf16 v[136:151], a[104:107], v[56:59], 0
    v_cvt_pk_bf16_f32 v61, v82, v83
    v_add_f32 v40, v40, v84
    v_add_f32 v41, v41, v85
    buffer_load_dwordx4 v12, s[20:23], s47 offen offset:2048 lds
    v_mfma_f32_32x32x16_bf16 v[152:167], a[108:111], v[56:59], 0
    v_cvt_pk_bf16_f32 v62, v84, v85
    v_add_f32 v40, v40, v86
    v_add_f32 v41, v41, v87
    buffer_load_dwordx4 v12, s[20:23], s47 offen offset:3072 lds
    v_mfma_f32_32x32x16_bf16 v[168:183], a[112:115], v[56:59], 0
    v_cvt_pk_bf16_f32 v63, v86, v87
    s_add_u32 m0, s50, 4096
    s_nop 0
    buffer_load_dwordx4 v13, s[20:23], s47 offen offset:0 lds
    v_mfma_f32_32x32x16_bf16 v[184:199], a[116:119], v[56:59], 0
    buffer_load_dwordx4 v13, s[20:23], s47 offen offset:1024 lds
    v_mfma_f32_32x32x16_bf16 v[104:119], a[120:123], v[60:63], v[104:119]
    buffer_load_dwordx4 v13, s[20:23], s47 offen offset:2048 lds
    s_waitcnt vmcnt(7)
    ds_read_b128 a[48:51], v4 offset:24576
    ds_read_b128 a[52:55], v5 offset:24576
    v_mfma_f32_32x32x16_bf16 v[120:135], a[124:127], v[60:63], v[120:135]
    buffer_load_dwordx4 v13, s[20:23], s47 offen offset:3072 lds
    ds_read_b128 a[56:59], v6 offset:24576
    ds_read_b128 a[60:63], v7 offset:24576
    v_mfma_f32_32x32x16_bf16 v[136:151], a[128:131], v[60:63], v[136:151]
    s_add_u32 m0, s50, 8192
    s_nop 0
    buffer_load_dwordx4 v14, s[20:23], s47 offen offset:0 lds
    ds_read_b128 a[64:67], v4 offset:24704
    ds_read_b128 a[68:71], v5 offset:24704
    v_mfma_f32_32x32x16_bf16 v[152:167], a[132:135], v[60:63], v[152:167]
    buffer_load_dwordx4 v14, s[20:23], s47 offen offset:1024 lds
    ds_read_b128 a[72:75], v6 offset:24704
    ds_read_b128 a[76:79], v7 offset:24704
    v_mfma_f32_32x32x16_bf16 v[168:183], a[136:139], v[60:63], v[168:183]
    buffer_load_dwordx4 v14, s[20:23], s47 offen offset:2048 lds
    ds_read_b128 a[80:83], v4 offset:24832
    ds_read_b128 a[84:87], v5 offset:24832
    v_mfma_f32_32x32x16_bf16 v[184:199], a[140:143], v[60:63], v[184:199]
    buffer_load_dwordx4 v14, s[20:23], s47 offen offset:3072 lds
    ds_read_b128 a[88:91], v6 offset:24832
    ds_read_b128 a[92:95], v7 offset:24832
    s_waitcnt lgkmcnt(4)
    v_mfma_f32_32x32x16_bf16 v[72:87], a[48:51], a[0:3], 0
    ds_read_b64_tr_b16 a[96:97], v8 offset:24576
    ds_read_b64_tr_b16 a[98:99], v9 offset:24576
    v_exp_f32 v88, v88
    v_exp_f32 v89, v89
    v_mfma_f32_32x32x16_bf16 v[72:87], a[52:55], a[4:7], v[72:87]
    ds_read_b64_tr_b16 a[100:101], v10 offset:24576
    ds_read_b64_tr_b16 a[102:103], v11 offset:24576
    v_exp_f32 v90, v90
    v_exp_f32 v91, v91
    v_mfma_f32_32x32x16_bf16 v[72:87], a[56:59], a[8:11], v[72:87]
    ds_read_b64_tr_b16 a[104:105], v8 offset:24704
    ds_read_b64_tr_b16 a[106:107], v9 offset:24704
    v_exp_f32 v92, v92
    v_exp_f32 v93, v93
    v_mfma_f32_32x32x16_bf16 v[72:87], a[60:63], a[12:15], v[72:87]
    ds_read_b64_tr_b16 a[108:109], v10 offset:24704
    ds_read_b64_tr_b16 a[110:111], v11 offset:24704
    v_exp_f32 v94, v94
    v_exp_f32 v95, v95
    v_mfma_f32_32x32x16_bf16 v[72:87], a[64:67], a[16:19], v[72:87]
    ds_read_b64_tr_b16 a[112:113], v8 offset:24832
    ds_read_b64_tr_b16 a[114:115], v9 offset:24832
    v_add_f32 v40, v40, v88
    v_add_f32 v41, v41, v89
    v_cvt_pk_bf16_f32 v64, v88, v89
    v_mfma_f32_32x32x16_bf16 v[72:87], a[68:71], a[20:23], v[72:87]
    ds_read_b64_tr_b16 a[116:117], v10 offset:24832
    ds_read_b64_tr_b16 a[118:119], v11 offset:24832
    v_add_f32 v40, v40, v90
    v_add_f32 v41, v41, v91
    v_cvt_pk_bf16_f32 v65, v90, v91
    v_mfma_f32_32x32x16_bf16 v[72:87], a[72:75], a[24:27], v[72:87]
    ds_read_b64_tr_b16 a[120:121], v8 offset:30720
    ds_read_b64_tr_b16 a[122:123], v9 offset:30720
    v_add_f32 v40, v40, v92
    v_add_f32 v41, v41, v93
    v_cvt_pk_bf16_f32 v66, v92, v93
    v_mfma_f32_32x32x16_bf16 v[72:87], a[76:79], a[28:31], v[72:87]
    ds_read_b64_tr_b16 a[124:125], v10 offset:30720
    ds_read_b64_tr_b16 a[126:127], v11 offset:30720
    v_add_f32 v40, v40, v94
    v_add_f32 v41, v41, v95
    v_cvt_pk_bf16_f32 v67, v94, v95
    s_waitcnt lgkmcnt(2)
    v_mfma_f32_32x32x16_bf16 v[72:87], a[80:83], a[32:35], v[72:87]
    ds_read_b64_tr_b16 a[128:129], v8 offset:30848
    ds_read_b64_tr_b16 a[130:131], v9 offset:30848
    v_exp_f32 v96, v96
    v_exp_f32 v97, v97
    v_mfma_f32_32x32x16_bf16 v[72:87], a[84:87], a[36:39], v[72:87]
    ds_read_b64_tr_b16 a[132:133], v10 offset:30848
    ds_read_b64_tr_b16 a[134:135], v11 offset:30848
    v_exp_f32 v98, v98
    v_exp_f32 v99, v99
    v_mfma_f32_32x32x16_bf16 v[72:87], a[88:91], a[40:43], v[72:87]
    ds_read_b64_tr_b16 a[136:137], v8 offset:30976
    ds_read_b64_tr_b16 a[138:139], v9 offset:30976
    v_exp_f32 v100, v100
    v_exp_f32 v101, v101
    v_mfma_f32_32x32x16_bf16 v[72:87], a[92:95], a[44:47], v[72:87]
    ds_read_b64_tr_b16 a[140:141], v10 offset:30976
    ds_read_b64_tr_b16 a[142:143], v11 offset:30976
    v_exp_f32 v102, v102
    v_exp_f32 v103, v103
    v_mfma_f32_32x32x16_bf16 v[104:119], a[144:147], v[64:67], v[104:119]
    s_cmp_eq_u32 s45, 270336
    s_cbranch_scc0 BK2_msk_7
    v_mov_b32 v48, 0
    v_cndmask_b32 v100, v100, v48, s[52:53]
    v_mov_b32 v101, 0
    v_mov_b32 v102, 0
    v_mov_b32 v103, 0
BK2_msk_7:
    v_add_f32 v40, v40, v96
    v_add_f32 v41, v41, v97
    s_add_u32 m0, s50, 12288
    s_nop 0
    buffer_load_dwordx4 v12, s[20:23], s48 offen offset:0 lds
    v_mfma_f32_32x32x16_bf16 v[120:135], a[148:151], v[64:67], v[120:135]
    v_cvt_pk_bf16_f32 v68, v96, v97
    v_add_f32 v40, v40, v98
    v_add_f32 v41, v41, v99
    buffer_load_dwordx4 v12, s[20:23], s48 offen offset:1024 lds
    v_mfma_f32_32x32x16_bf16 v[136:151], a[152:155], v[64:67], v[136:151]
    v_cvt_pk_bf16_f32 v69, v98, v99
    v_add_f32 v40, v40, v100
    v_add_f32 v41, v41, v101
    buffer_load_dwordx4 v12, s[20:23], s48 offen offset:2048 lds
    v_mfma_f32_32x32x16_bf16 v[152:167], a[156:159], v[64:67], v[152:167]
    v_cvt_pk_bf16_f32 v70, v100, v101
    v_add_f32 v40, v40, v102
    v_add_f32 v41, v41, v103
    buffer_load_dwordx4 v12, s[20:23], s48 offen offset:3072 lds
    v_mfma_f32_32x32x16_bf16 v[168:183], a[160:163], v[64:67], v[168:183]
    v_cvt_pk_bf16_f32 v71, v102, v103
    s_add_u32 m0, s50, 16384
    s_nop 0
    buffer_load_dwordx4 v13, s[20:23], s48 offen offset:0 lds
    v_mfma_f32_32x32x16_bf16 v[184:199], a[164:167], v[64:67], v[184:199]
    buffer_load_dwordx4 v13, s[20:23], s48 offen offset:1024 lds
    v_mfma_f32_32x32x16_bf16 v[104:119], a[168:171], v[68:71], v[104:119]
    buffer_load_dwordx4 v13, s[20:23], s48 offen offset:2048 lds
    s_waitcnt vmcnt(7)
    ds_read_b128 a[48:51], v4 offset:0
    ds_read_b128 a[52:55], v5 offset:0
    v_mfma_f32_32x32x16_bf16 v[120:135], a[172:175], v[68:71], v[120:135]
    buffer_load_dwordx4 v13, s[20:23], s48 offen offset:3072 lds
    ds_read_b128 a[56:59], v6 offset:0
    ds_read_b128 a[60:63], v7 offset:0
    v_mfma_f32_32x32x16_bf16 v[136:151], a[176:179], v[68:71], v[136:151]
    s_add_u32 m0, s50, 20480
    s_nop 0
    buffer_load_dwordx4 v14, s[20:23], s48 offen offset:0 lds
    ds_read_b128 a[64:67], v4 offset:128
    ds_read_b128 a[68:71], v5 offset:128
    v_mfma_f32_32x32x16_bf16 v[152:167], a[180:183], v[68:71], v[152:167]
    buffer_load_dwordx4 v14, s[20:23], s48 offen offset:1024 lds
    ds_read_b128 a[72:75], v6 offset:128
    ds_read_b128 a[76:79], v7 offset:128
    v_mfma_f32_32x32x16_bf16 v[168:183], a[184:187], v[68:71], v[168:183]
    buffer_load_dwordx4 v14, s[20:23], s48 offen offset:2048 lds
    ds_read_b128 a[80:83], v4 offset:256
    ds_read_b128 a[84:87], v5 offset:256
    v_mfma_f32_32x32x16_bf16 v[184:199], a[188:191], v[68:71], v[184:199]
    buffer_load_dwordx4 v14, s[20:23], s48 offen offset:3072 lds
    ds_read_b128 a[88:91], v6 offset:256
    ds_read_b128 a[92:95], v7 offset:256
    s_waitcnt lgkmcnt(4)
    v_mfma_f32_32x32x16_bf16 v[88:103], a[48:51], a[0:3], 0
    ds_read_b64_tr_b16 a[144:145], v8 offset:0
    ds_read_b64_tr_b16 a[146:147], v9 offset:0
    v_exp_f32 v72, v72
    v_exp_f32 v73, v73
    v_mfma_f32_32x32x16_bf16 v[88:103], a[52:55], a[4:7], v[88:103]
    ds_read_b64_tr_b16 a[148:149], v10 offset:0
    ds_read_b64_tr_b16 a[150:151], v11 offset:0
    v_exp_f32 v74, v74
    v_exp_f32 v75, v75
    v_mfma_f32_32x32x16_bf16 v[88:103], a[56:59], a[8:11], v[88:103]
    ds_read_b64_tr_b16 a[152:153], v8 offset:128
    ds_read_b64_tr_b16 a[154:155], v9 offset:128
    v_exp_f32 v76, v76
    v_exp_f32 v77, v77
    v_mfma_f32_32x32x16_bf16 v[88:103], a[60:63], a[12:15], v[88:103]
    ds_read_b64_tr_b16 a[156:157], v10 offset:128
    ds_read_b64_tr_b16 a[158:159], v11 offset:128
    v_exp_f32 v78, v78
    v_exp_f32 v79, v79
    v_mfma_f32_32x32x16_bf16 v[88:103], a[64:67], a[16:19], v[88:103]
    ds_read_b64_tr_b16 a[160:161], v8 offset:256
    ds_read_b64_tr_b16 a[162:163], v9 offset:256
    v_add_f32 v40, v40, v72
    v_add_f32 v41, v41, v73
    v_cvt_pk_bf16_f32 v56, v72, v73
    v_mfma_f32_32x32x16_bf16 v[88:103], a[68:71], a[20:23], v[88:103]
    ds_read_b64_tr_b16 a[164:165], v10 offset:256
    ds_read_b64_tr_b16 a[166:167], v11 offset:256
    v_add_f32 v40, v40, v74
    v_add_f32 v41, v41, v75
    v_cvt_pk_bf16_f32 v57, v74, v75
    v_mfma_f32_32x32x16_bf16 v[88:103], a[72:75], a[24:27], v[88:103]
    ds_read_b64_tr_b16 a[168:169], v8 offset:6144
    ds_read_b64_tr_b16 a[170:171], v9 offset:6144
    v_add_f32 v40, v40, v76
    v_add_f32 v41, v41, v77
    v_cvt_pk_bf16_f32 v58, v76, v77
    v_mfma_f32_32x32x16_bf16 v[88:103], a[76:79], a[28:31], v[88:103]
    ds_read_b64_tr_b16 a[172:173], v10 offset:6144
    ds_read_b64_tr_b16 a[174:175], v11 offset:6144
    v_add_f32 v40, v40, v78
    v_add_f32 v41, v41, v79
    v_cvt_pk_bf16_f32 v59, v78, v79
    s_waitcnt lgkmcnt(2)
    v_mfma_f32_32x32x16_bf16 v[88:103], a[80:83], a[32:35], v[88:103]
    ds_read_b64_tr_b16 a[176:177], v8 offset:6272
    ds_read_b64_tr_b16 a[178:179], v9 offset:6272
    v_exp_f32 v80, v80
    v_exp_f32 v81, v81
    v_mfma_f32_32x32x16_bf16 v[88:103], a[84:87], a[36:39], v[88:103]
    ds_read_b64_tr_b16 a[180:181], v10 offset:6272
    ds_read_b64_tr_b16 a[182:183], v11 offset:6272
    v_exp_f32 v82, v82
    v_exp_f32 v83, v83
    v_mfma_f32_32x32x16_bf16 v[88:103], a[88:91], a[40:43], v[88:103]
    ds_read_b64_tr_b16 a[184:185], v8 offset:6400
    ds_read_b64_tr_b16 a[186:187], v9 offset:6400
    v_exp_f32 v84, v84
    v_exp_f32 v85, v85
    v_mfma_f32_32x32x16_bf16 v[88:103], a[92:95], a[44:47], v[88:103]
    ds_read_b64_tr_b16 a[188:189], v10 offset:6400
    ds_read_b64_tr_b16 a[190:191], v11 offset:6400
    v_exp_f32 v86, v86
    v_exp_f32 v87, v87
    v_mfma_f32_32x32x16_bf16 v[104:119], a[96:99], v[56:59], v[104:119]
    s_cmp_eq_u32 s46, 270336
    s_cbranch_scc0 BK2_msk_8
    v_mov_b32 v48, 0
    v_cndmask_b32 v84, v84, v48, s[52:53]
    v_mov_b32 v85, 0
    v_mov_b32 v86, 0
    v_mov_b32 v87, 0
BK2_msk_8:
    v_add_f32 v40, v40, v80
    v_add_f32 v41, v41, v81
    s_add_u32 m0, s50, 24576
    s_nop 0
    buffer_load_dwordx4 v12, s[20:23], s49 offen offset:0 lds
    v_mfma_f32_32x32x16_bf16 v[120:135], a[100:103], v[56:59], v[120:135]
    v_cvt_pk_bf16_f32 v60, v80, v81
    v_add_f32 v40, v40, v82
    v_add_f32 v41, v41, v83
    buffer_load_dwordx4 v12, s[20:23], s49 offen offset:1024 lds
    v_mfma_f32_32x32x16_bf16 v[136:151], a[104:107], v[56:59], v[136:151]
    v_cvt_pk_bf16_f32 v61, v82, v83
    v_add_f32 v40, v40, v84
    v_add_f32 v41, v41, v85
    buffer_load_dwordx4 v12, s[20:23], s49 offen offset:2048 lds
    v_mfma_f32_32x32x16_bf16 v[152:167], a[108:111], v[56:59], v[152:167]
    v_cvt_pk_bf16_f32 v62, v84, v85
    v_add_f32 v40, v40, v86
    v_add_f32 v41, v41, v87
    buffer_load_dwordx4 v12, s[20:23], s49 offen offset:3072 lds
    v_mfma_f32_32x32x16_bf16 v[168:183], a[112:115], v[56:59], v[168:183]
    v_cvt_pk_bf16_f32 v63, v86, v87
    s_add_u32 m0, s50, 28672
    s_nop 0
    buffer_load_dwordx4 v13, s[20:23], s49 offen offset:0 lds
    v_mfma_f32_32x32x16_bf16 v[184:199], a[116:119], v[56:59], v[184:199]
    buffer_load_dwordx4 v13, s[20:23], s49 offen offset:1024 lds
    v_mfma_f32_32x32x16_bf16 v[104:119], a[120:123], v[60:63], v[104:119]
    buffer_load_dwordx4 v13, s[20:23], s49 offen offset:2048 lds
    s_waitcnt vmcnt(7)
    ds_read_b128 a[48:51], v4 offset:12288
    ds_read_b128 a[52:55], v5 offset:12288
    v_mfma_f32_32x32x16_bf16 v[120:135], a[124:127], v[60:63], v[120:135]
    buffer_load_dwordx4 v13, s[20:23], s49 offen offset:3072 lds
    ds_read_b128 a[56:59], v6 offset:12288
    ds_read_b128 a[60:63], v7 offset:12288
    v_mfma_f32_32x32x16_bf16 v[136:151], a[128:131], v[60:63], v[136:151]
    s_add_u32 m0, s50, 32768
    s_nop 0
    buffer_load_dwordx4 v14, s[20:23], s49 offen offset:0 lds
    ds_read_b128 a[64:67], v4 offset:12416
    ds_read_b128 a[68:71], v5 offset:12416
    v_mfma_f32_32x32x16_bf16 v[152:167], a[132:135], v[60:63], v[152:167]
    buffer_load_dwordx4 v14, s[20:23], s49 offen offset:1024 lds
    ds_read_b128 a[72:75], v6 offset:12416
    ds_read_b128 a[76:79], v7 offset:12416
    v_mfma_f32_32x32x16_bf16 v[168:183], a[136:139], v[60:63], v[168:183]
    buffer_load_dwordx4 v14, s[20:23], s49 offen offset:2048 lds
    ds_read_b128 a[80:83], v4 offset:12544
    ds_read_b128 a[84:87], v5 offset:12544
    v_mfma_f32_32x32x16_bf16 v[184:199], a[140:143], v[60:63], v[184:199]
    buffer_load_dwordx4 v14, s[20:23], s49 offen offset:3072 lds
    ds_read_b128 a[88:91], v6 offset:12544
    ds_read_b128 a[92:95], v7 offset:12544
    s_waitcnt lgkmcnt(4)
    v_mfma_f32_32x32x16_bf16 v[72:87], a[48:51], a[0:3], 0
    ds_read_b64_tr_b16 a[96:97], v8 offset:12288
    ds_read_b64_tr_b16 a[98:99], v9 offset:12288
    v_exp_f32 v88, v88
    v_exp_f32 v89, v89
    v_mfma_f32_32x32x16_bf16 v[72:87], a[52:55], a[4:7], v[72:87]
    ds_read_b64_tr_b16 a[100:101], v10 offset:12288
    ds_read_b64_tr_b16 a[102:103], v11 offset:12288
    v_exp_f32 v90, v90
    v_exp_f32 v91, v91
    v_mfma_f32_32x32x16_bf16 v[72:87], a[56:59], a[8:11], v[72:87]
    ds_read_b64_tr_b16 a[104:105], v8 offset:12416
    ds_read_b64_tr_b16 a[106:107], v9 offset:12416
    v_exp_f32 v92, v92
    v_exp_f32 v93, v93
    v_mfma_f32_32x32x16_bf16 v[72:87], a[60:63], a[12:15], v[72:87]
    ds_read_b64_tr_b16 a[108:109], v10 offset:12416
    ds_read_b64_tr_b16 a[110:111], v11 offset:12416
    v_exp_f32 v94, v94
    v_exp_f32 v95, v95
    v_mfma_f32_32x32x16_bf16 v[72:87], a[64:67], a[16:19], v[72:87]
    ds_read_b64_tr_b16 a[112:113], v8 offset:12544
    ds_read_b64_tr_b16 a[114:115], v9 offset:12544
    v_add_f32 v40, v40, v88
    v_add_f32 v41, v41, v89
    v_cvt_pk_bf16_f32 v64, v88, v89
    v_mfma_f32_32x32x16_bf16 v[72:87], a[68:71], a[20:23], v[72:87]
    ds_read_b64_tr_b16 a[116:117], v10 offset:12544
    ds_read_b64_tr_b16 a[118:119], v11 offset:12544
    v_add_f32 v40, v40, v90
    v_add_f32 v41, v41, v91
    v_cvt_pk_bf16_f32 v65, v90, v91
    v_mfma_f32_32x32x16_bf16 v[72:87], a[72:75], a[24:27], v[72:87]
    ds_read_b64_tr_b16 a[120:121], v8 offset:18432
    ds_read_b64_tr_b16 a[122:123], v9 offset:18432
    v_add_f32 v40, v40, v92
    v_add_f32 v41, v41, v93
    v_cvt_pk_bf16_f32 v66, v92, v93
    v_mfma_f32_32x32x16_bf16 v[72:87], a[76:79], a[28:31], v[72:87]
    ds_read_b64_tr_b16 a[124:125], v10 offset:18432
    ds_read_b64_tr_b16 a[126:127], v11 offset:18432
    v_add_f32 v40, v40, v94
    v_add_f32 v41, v41, v95
    v_cvt_pk_bf16_f32 v67, v94, v95
    s_waitcnt lgkmcnt(2)
    v_mfma_f32_32x32x16_bf16 v[72:87], a[80:83], a[32:35], v[72:87]
    ds_read_b64_tr_b16 a[128:129], v8 offset:18560
    ds_read_b64_tr_b16 a[130:131], v9 offset:18560
    v_exp_f32 v96, v96
    v_exp_f32 v97, v97
    v_mfma_f32_32x32x16_bf16 v[72:87], a[84:87], a[36:39], v[72:87]
    ds_read_b64_tr_b16 a[132:133], v10 offset:18560
    ds_read_b64_tr_b16 a[134:135], v11 offset:18560
    v_exp_f32 v98, v98
    v_exp_f32 v99, v99
    v_mfma_f32_32x32x16_bf16 v[72:87], a[88:91], a[40:43], v[72:87]
    ds_read_b64_tr_b16 a[136:137], v8 offset:18688
    ds_read_b64_tr_b16 a[138:139], v9 offset:18688
    v_exp_f32 v100, v100
    v_exp_f32 v101, v101
    v_mfma_f32_32x32x16_bf16 v[72:87], a[92:95], a[44:47], v[72:87]
    ds_read_b64_tr_b16 a[140:141], v10 offset:18688
    ds_read_b64_tr_b16 a[142:143], v11 offset:18688
    v_exp_f32 v102, v102
    v_exp_f32 v103, v103
    v_mfma_f32_32x32x16_bf16 v[104:119], a[144:147], v[64:67], v[104:119]
    s_cmp_eq_u32 s47, 270336
    s_cbranch_scc0 BK2_msk_9
    v_mov_b32 v48, 0
    v_cndmask_b32 v100, v100, v48, s[52:53]
    v_mov_b32 v101, 0
    v_mov_b32 v102, 0
    v_mov_b32 v103, 0
BK2_msk_9:
    v_add_f32 v40, v40, v96
    v_add_f32 v41, v41, v97
    s_mov_b32 s43, 73728
    buffer_load_dwordx4 a[192:195], v37, s[32:35], s43 offen offset:0
    v_mfma_f32_32x32x16_bf16 v[120:135], a[148:151], v[64:67], v[120:135]
    v_cvt_pk_bf16_f32 v68, v96, v97
    v_add_f32 v40, v40, v98
    v_add_f32 v41, v41, v99
    buffer_load_dwordx4 a[196:199], v37, s[32:35], s43 offen offset:1024
    v_mfma_f32_32x32x16_bf16 v[136:151], a[152:155], v[64:67], v[136:151]
    v_cvt_pk_bf16_f32 v69, v98, v99
    v_add_f32 v40, v40, v100
    v_add_f32 v41, v41, v101
    buffer_load_dwordx4 a[200:203], v37, s[32:35], s43 offen offset:2048
    v_mfma_f32_32x32x16_bf16 v[152:167], a[156:159], v[64:67], v[152:167]
    v_cvt_pk_bf16_f32 v70, v100, v101
    v_add_f32 v40, v40, v102
    v_add_f32 v41, v41, v103
    buffer_load_dwordx4 a[204:207], v37, s[32:35], s43 offen offset:3072
    v_mfma_f32_32x32x16_bf16 v[168:183], a[160:163], v[64:67], v[168:183]
    v_cvt_pk_bf16_f32 v71, v102, v103
    s_mov_b32 s43, 77824
    buffer_load_dwordx4 a[208:211], v37, s[32:35], s43 offen offset:0
    v_mfma_f32_32x32x16_bf16 v[184:199], a[164:167], v[64:67], v[184:199]
    buffer_load_dwordx4 a[212:215], v37, s[32:35], s43 offen offset:1024
    v_mfma_f32_32x32x16_bf16 v[104:119], a[168:171], v[68:71], v[104:119]
    s_waitcnt vmcnt(6)
    ds_read_b128 a[48:51], v4 offset:24576
    ds_read_b128 a[52:55], v5 offset:24576
    buffer_load_dwordx4 a[216:219], v37, s[32:35], s43 offen offset:2048
    v_mfma_f32_32x32x16_bf16 v[120:135], a[172:175], v[68:71], v[120:135]
    ds_read_b128 a[56:59], v6 offset:24576
    ds_read_b128 a[60:63], v7 offset:24576
    buffer_load_dwordx4 a[220:223], v37, s[32:35], s43 offen offset:3072
    v_mfma_f32_32x32x16_bf16 v[136:151], a[176:179], v[68:71], v[136:151]
    ds_read_b128 a[64:67], v4 offset:24704
    ds_read_b128 a[68:71], v5 offset:24704
    s_mov_b32 s43, 81920
    buffer_load_dwordx4 a[224:227], v37, s[32:35], s43 offen offset:0
    v_mfma_f32_32x32x16_bf16 v[152:167], a[180:183], v[68:71], v[152:167]
    ds_read_b128 a[72:75], v6 offset:24704
    ds_read_b128 a[76:79], v7 offset:24704
    buffer_load_dwordx4 a[228:231], v37, s[32:35], s43 offen offset:1024
    v_mfma_f32_32x32x16_bf16 v[168:183], a[184:187], v[68:71], v[168:183]
    ds_read_b128 a[80:83], v4 offset:24832
    ds_read_b128 a[84:87], v5 offset:24832
    buffer_load_dwordx4 a[232:235], v37, s[32:35], s43 offen offset:2048
    v_mfma_f32_32x32x16_bf16 v[184:199], a[188:191], v[68:71], v[184:199]
    ds_read_b128 a[88:91], v6 offset:24832
    ds_read_b128 a[92:95], v7 offset:24832
    buffer_load_dwordx4 a[236:239], v37, s[32:35], s43 offen offset:3072
    s_waitcnt lgkmcnt(4)
    v_mfma_f32_32x32x16_bf16 v[88:103], a[48:51], a[0:3], 0
    ds_read_b64_tr_b16 a[144:145], v8 offset:24576
    ds_read_b64_tr_b16 a[146:147], v9 offset:24576
    v_exp_f32 v72, v72
    v_exp_f32 v73, v73
    s_mov_b32 s43, 86016
    buffer_load_dwordx4 a[240:243], v37, s[32:35], s43 offen offset:0
    v_mfma_f32_32x32x16_bf16 v[88:103], a[52:55], a[4:7], v[88:103]
    ds_read_b64_tr_b16 a[148:149], v10 offset:24576
    ds_read_b64_tr_b16 a[150:151], v11 offset:24576
    v_exp_f32 v74, v74
    v_exp_f32 v75, v75
    v_mfma_f32_32x32x16_bf16 v[88:103], a[56:59], a[8:11], v[88:103]
    ds_read_b64_tr_b16 a[152:153], v8 offset:24704
    ds_read_b64_tr_b16 a[154:155], v9 offset:24704
    v_exp_f32 v76, v76
    v_exp_f32 v77, v77
    buffer_load_dwordx4 a[244:247], v37, s[32:35], s43 offen offset:1024
    v_mfma_f32_32x32x16_bf16 v[88:103], a[60:63], a[12:15], v[88:103]
    ds_read_b64_tr_b16 a[156:157], v10 offset:24704
    ds_read_b64_tr_b16 a[158:159], v11 offset:24704
    v_exp_f32 v78, v78
    v_exp_f32 v79, v79
    v_mfma_f32_32x32x16_bf16 v[88:103], a[64:67], a[16:19], v[88:103]
    ds_read_b64_tr_b16 a[160:161], v8 offset:24832
    ds_read_b64_tr_b16 a[162:163], v9 offset:24832
    v_add_f32 v40, v40, v72
    v_add_f32 v41, v41, v73
    v_cvt_pk_bf16_f32 v56, v72, v73
    buffer_load_dwordx4 a[248:251], v37, s[32:35], s43 offen offset:2048
    v_mfma_f32_32x32x16_bf16 v[88:103], a[68:71], a[20:23], v[88:103]
    ds_read_b64_tr_b16 a[164:165], v10 offset:24832
    ds_read_b64_tr_b16 a[166:167], v11 offset:24832
    v_add_f32 v40, v40, v74
    v_add_f32 v41, v41, v75
    v_cvt_pk_bf16_f32 v57, v74, v75
    v_mfma_f32_32x32x16_bf16 v[88:103], a[72:75], a[24:27], v[88:103]
    ds_read_b64_tr_b16 a[168:169], v8 offset:30720
    ds_read_b64_tr_b16 a[170:171], v9 offset:30720
    v_add_f32 v40, v40, v76
    v_add_f32 v41, v41, v77
    v_cvt_pk_bf16_f32 v58, v76, v77
    buffer_load_dwordx4 a[252:255], v37, s[32:35], s43 offen offset:3072
    v_mfma_f32_32x32x16_bf16 v[88:103], a[76:79], a[28:31], v[88:103]
    ds_read_b64_tr_b16 a[172:173], v10 offset:30720
    ds_read_b64_tr_b16 a[174:175], v11 offset:30720
    v_add_f32 v40, v40, v78
    v_add_f32 v41, v41, v79
    v_cvt_pk_bf16_f32 v59, v78, v79
    s_waitcnt lgkmcnt(2)
    v_mfma_f32_32x32x16_bf16 v[88:103], a[80:83], a[32:35], v[88:103]
    ds_read_b64_tr_b16 a[176:177], v8 offset:30848
    ds_read_b64_tr_b16 a[178:179], v9 offset:30848
    v_exp_f32 v80, v80
    v_exp_f32 v81, v81
    s_mov_b32 s43, 90112
    buffer_load_dwordx4 v[212:215], v37, s[32:35], s43 offen offset:0
    v_mfma_f32_32x32x16_bf16 v[88:103], a[84:87], a[36:39], v[88:103]
    ds_read_b64_tr_b16 a[180:181], v10 offset:30848
    ds_read_b64_tr_b16 a[182:183], v11 offset:30848
    v_exp_f32 v82, v82
    v_exp_f32 v83, v83
    v_mfma_f32_32x32x16_bf16 v[88:103], a[88:91], a[40:43], v[88:103]
    ds_read_b64_tr_b16 a[184:185], v8 offset:30976
    ds_read_b64_tr_b16 a[186:187], v9 offset:30976
    v_exp_f32 v84, v84
    v_exp_f32 v85, v85
    buffer_load_dwordx4 v[216:219], v37, s[32:35], s43 offen offset:1024
    v_mfma_f32_32x32x16_bf16 v[88:103], a[92:95], a[44:47], v[88:103]
    ds_read_b64_tr_b16 a[188:189], v10 offset:30976
    ds_read_b64_tr_b16 a[190:191], v11 offset:30976
    v_exp_f32 v86, v86
    v_exp_f32 v87, v87
    v_mfma_f32_32x32x16_bf16 v[104:119], a[96:99], v[56:59], v[104:119]
    s_cmp_eq_u32 s48, 270336
    s_cbranch_scc0 BK2_msk_10
    v_mov_b32 v48, 0
    v_cndmask_b32 v84, v84, v48, s[52:53]
    v_mov_b32 v85, 0
    v_mov_b32 v86, 0
    v_mov_b32 v87, 0
BK2_msk_10:
    v_add_f32 v40, v40, v80
    v_add_f32 v41, v41, v81
    buffer_load_dwordx4 v[200:203], v50, s[20:23], 0 offen
    v_mfma_f32_32x32x16_bf16 v[120:135], a[100:103], v[56:59], v[120:135]
    v_cvt_pk_bf16_f32 v60, v80, v81
    v_add_f32 v40, v40, v82
    v_add_f32 v41, v41, v83
    buffer_load_dwordx2 v[204:205], v51, s[20:23], 0 offen
    v_mfma_f32_32x32x16_bf16 v[136:151], a[104:107], v[56:59], v[136:151]
    v_cvt_pk_bf16_f32 v61, v82, v83
    v_add_f32 v40, v40, v84
    v_add_f32 v41, v41, v85
    buffer_load_dwordx2 v[220:221], v15, s[24:27], 0 offen offset:0
    v_exp_f32 v88, v88
    v_exp_f32 v89, v89
    v_mfma_f32_32x32x16_bf16 v[152:167], a[108:111], v[56:59], v[152:167]
    v_cvt_pk_bf16_f32 v62, v84, v85
    v_add_f32 v40, v40, v86
    v_add_f32 v41, v41, v87
    buffer_load_dwordx4 v[206:209], v50, s[20:23], s67 offen
    v_exp_f32 v90, v90
    v_exp_f32 v91, v91
    v_mfma_f32_32x32x16_bf16 v[168:183], a[112:115], v[56:59], v[168:183]
    v_cvt_pk_bf16_f32 v63, v86, v87
    buffer_load_dwordx2 v[210:211], v51, s[20:23], s67 offen
    v_exp_f32 v92, v92
    v_exp_f32 v93, v93
    v_mfma_f32_32x32x16_bf16 v[184:199], a[116:119], v[56:59], v[184:199]
    buffer_load_dwordx2 v[222:223], v15, s[24:27], 0 offen offset:1024
    v_exp_f32 v94, v94
    v_exp_f32 v95, v95
    v_mfma_f32_32x32x16_bf16 v[104:119], a[120:123], v[60:63], v[104:119]
    v_exp_f32 v96, v96
    v_exp_f32 v97, v97
    v_mfma_f32_32x32x16_bf16 v[120:135], a[124:127], v[60:63], v[120:135]
    v_exp_f32 v98, v98
    v_exp_f32 v99, v99
    v_mfma_f32_32x32x16_bf16 v[136:151], a[128:131], v[60:63], v[136:151]
    v_exp_f32 v100, v100
    v_exp_f32 v101, v101
    v_mfma_f32_32x32x16_bf16 v[152:167], a[132:135], v[60:63], v[152:167]
    v_exp_f32 v102, v102
    v_exp_f32 v103, v103
    v_mfma_f32_32x32x16_bf16 v[168:183], a[136:139], v[60:63], v[168:183]
    s_cmp_eq_u32 s49, 270336
    s_cbranch_scc0 BK2_msk_11
    v_mov_b32 v48, 0
    v_cndmask_b32 v100, v100, v48, s[52:53]
    v_mov_b32 v101, 0
    v_mov_b32 v102, 0
    v_mov_b32 v103, 0
BK2_msk_11:
    v_cvt_pk_bf16_f32 v64, v88, v89
    v_cvt_pk_bf16_f32 v65, v90, v91
    v_cvt_pk_bf16_f32 v66, v92, v93
    v_cvt_pk_bf16_f32 v67, v94, v95
    v_mfma_f32_32x32x16_bf16 v[184:199], a[140:143], v[60:63], v[184:199]
    v_cvt_pk_bf16_f32 v68, v96, v97
    v_cvt_pk_bf16_f32 v69, v98, v99
    v_cvt_pk_bf16_f32 v70, v100, v101
    v_cvt_pk_bf16_f32 v71, v102, v103
    v_mfma_f32_32x32x16_bf16 v[104:119], a[144:147], v[64:67], v[104:119]
    v_add_f32 v42, v42, v88
    v_add_f32 v43, v43, v89
    v_add_f32 v42, v42, v90
    v_add_f32 v43, v43, v91
    v_mfma_f32_32x32x16_bf16 v[104:119], a[168:171], v[68:71], v[104:119]
    v_add_f32 v42, v42, v92
    v_add_f32 v43, v43, v93
    v_add_f32 v42, v42, v94
    v_add_f32 v43, v43, v95
    v_mfma_f32_32x32x16_bf16 v[120:135], a[148:151], v[64:67], v[120:135]
    v_add_f32 v42, v42, v96
    v_add_f32 v43, v43, v97
    v_add_f32 v42, v42, v98
    v_add_f32 v43, v43, v99
    s_waitcnt lgkmcnt(0)
    v_mfma_f32_32x32x16_bf16 v[120:135], a[172:175], v[68:71], v[120:135]
    v_add_f32 v42, v42, v100
    v_add_f32 v43, v43, v101
    v_add_f32 v42, v42, v102
    v_add_f32 v43, v43, v103
    v_cvt_pk_bf16_f32 v72, v104, v105
    v_cvt_pk_bf16_f32 v73, v106, v107
    v_cvt_pk_bf16_f32 v74, v108, v109
    v_cvt_pk_bf16_f32 v75, v110, v111
    ds_write_b128 v21, v[72:75] offset:0
    v_cvt_pk_bf16_f32 v76, v112, v113
    v_cvt_pk_bf16_f32 v77, v114, v115
    v_cvt_pk_bf16_f32 v78, v116, v117
    v_cvt_pk_bf16_f32 v79, v118, v119
    ds_write_b128 v22, v[76:79] offset:0
    v_mfma_f32_32x32x16_bf16 v[136:151], a[152:155], v[64:67], v[136:151]
    s_cmp_eq_u32 s49, 1048576
    s_cbranch_scc1 BK2_dum_12
    v_add_f32 v40, v40, v42
    v_add_f32 v41, v41, v43
BK2_dum_12:
    v_add_f32 v40, v40, v41
    v_mov_b32 v41, v40
    v_mfma_f32_32x32x16_bf16 v[136:151], a[176:179], v[68:71], v[136:151]
    v_cvt_pk_bf16_f32 v80, v120, v121
    v_cvt_pk_bf16_f32 v81, v122, v123
    v_cvt_pk_bf16_f32 v82, v124, v125
    v_cvt_pk_bf16_f32 v83, v126, v127
    ds_write_b128 v23, v[80:83] offset:0
    v_cvt_pk_bf16_f32 v84, v128, v129
    v_cvt_pk_bf16_f32 v85, v130, v131
    v_cvt_pk_bf16_f32 v86, v132, v133
    v_cvt_pk_bf16_f32 v87, v134, v135
    ds_write_b128 v24, v[84:87] offset:0
    v_mfma_f32_32x32x16_bf16 v[152:167], a[156:159], v[64:67], v[152:167]
    v_permlane32_swap_b32 v40, v41
    v_add_f32 v40, v40, v41
    ds_write_b32 v38, v40
    v_mfma_f32_32x32x16_bf16 v[152:167], a[180:183], v[68:71], v[152:167]
    s_waitcnt lgkmcnt(2)
    v_cvt_pk_bf16_f32 v72, v136, v137
    v_cvt_pk_bf16_f32 v73, v138, v139
    v_cvt_pk_bf16_f32 v74, v140, v141
    v_cvt_pk_bf16_f32 v75, v142, v143
    ds_write_b128 v21, v[72:75] offset:128
    v_cvt_pk_bf16_f32 v76, v144, v145
    v_cvt_pk_bf16_f32 v77, v146, v147
    v_cvt_pk_bf16_f32 v78, v148, v149
    v_cvt_pk_bf16_f32 v79, v150, v151
    ds_write_b128 v22, v[76:79] offset:128
    v_mfma_f32_32x32x16_bf16 v[168:183], a[160:163], v[64:67], v[168:183]
    v_mfma_f32_32x32x16_bf16 v[168:183], a[184:187], v[68:71], v[168:183]
    v_cvt_pk_bf16_f32 v80, v152, v153
    v_cvt_pk_bf16_f32 v81, v154, v155
    v_cvt_pk_bf16_f32 v82, v156, v157
    v_cvt_pk_bf16_f32 v83, v158, v159
    ds_write_b128 v23, v[80:83] offset:128
    s_waitcnt lgkmcnt(2)
    v_cvt_pk_bf16_f32 v84, v160, v161
    v_cvt_pk_bf16_f32 v85, v162, v163
    v_cvt_pk_bf16_f32 v86, v164, v165
    v_cvt_pk_bf16_f32 v87, v166, v167
    ds_write_b128 v24, v[84:87] offset:128
    v_mfma_f32_32x32x16_bf16 v[184:199], a[164:167], v[64:67], v[184:199]
    v_mfma_f32_32x32x16_bf16 v[184:199], a[188:191], v[68:71], v[184:199]
    v_cvt_pk_bf16_f32 v72, v168, v169
    v_cvt_pk_bf16_f32 v73, v170, v171
    v_cvt_pk_bf16_f32 v74, v172, v173
    v_cvt_pk_bf16_f32 v75, v174, v175
    ds_write_b128 v21, v[72:75] offset:256
    s_waitcnt lgkmcnt(2)
    v_cvt_pk_bf16_f32 v76, v176, v177
    v_cvt_pk_bf16_f32 v77, v178, v179
    v_cvt_pk_bf16_f32 v78, v180, v181
    v_cvt_pk_bf16_f32 v79, v182, v183
    ds_write_b128 v22, v[76:79] offset:256
    s_nop 0
    v_cvt_pk_bf16_f32 v80, v184, v185
    v_cvt_pk_bf16_f32 v81, v186, v187
    v_cvt_pk_bf16_f32 v82, v188, v189
    v_cvt_pk_bf16_f32 v83, v190, v191
    ds_write_b128 v23, v[80:83] offset:256
    s_waitcnt lgkmcnt(2)
    v_cvt_pk_bf16_f32 v84, v192, v193
    v_cvt_pk_bf16_f32 v85, v194, v195
    v_cvt_pk_bf16_f32 v86, v196, v197
    v_cvt_pk_bf16_f32 v87, v198, v199
    ds_write_b128 v24, v[84:87] offset:256
    s_waitcnt lgkmcnt(0)
    s_barrier
K2_reduce:
    ds_read_b128 v[72:75], v39 offset:0
    ds_read_b128 v[76:79], v39 offset:256
    ds_read_b128 v[104:107], v25 offset:0
    ds_read_b128 v[108:111], v16 offset:0
    ds_read_b128 v[112:115], v25 offset:6144
    ds_read_b128 v[116:119], v16 offset:6144
    ds_read_b128 v[120:123], v26 offset:0
    ds_read_b128 v[124:127], v17 offset:0
    ds_read_b128 v[128:131], v26 offset:6144
    ds_read_b128 v[132:135], v17 offset:6144
    ds_read_b128 v[136:139], v27 offset:0
    ds_read_b128 v[140:143], v18 offset:0
    ds_read_b128 v[144:147], v27 offset:6144
    ds_read_b128 v[148:151], v18 offset:6144
    s_waitcnt vmcnt(5)
    v_lshlrev_b32 v152, 16, v200
    v_and_b32 v153, s55, v200
    v_lshlrev_b32 v154, 16, v201
    v_and_b32 v155, s55, v201
    s_waitcnt vmcnt(3)
    v_pk_fma_f32 v[152:153], v[152:153], v[220:221], v[220:221] op_sel:[0,1,0] op_sel_hi:[1,1,0]
    v_pk_fma_f32 v[154:155], v[154:155], v[220:221], v[220:221] op_sel:[0,1,0] op_sel_hi:[1,1,0]
    v_lshlrev_b32 v160, 16, v202
    v_and_b32 v161, s55, v202
    v_lshlrev_b32 v162, 16, v203
    v_and_b32 v163, s55, v203
    v_pk_fma_f32 v[160:161], v[160:161], v[220:221], v[220:221] op_sel:[0,1,0] op_sel_hi:[1,1,0]
    v_pk_fma_f32 v[162:163], v[162:163], v[220:221], v[220:221] op_sel:[0,1,0] op_sel_hi:[1,1,0]
    v_lshlrev_b32 v168, 16, v204
    v_and_b32 v169, s55, v204
    v_lshlrev_b32 v170, 16, v205
    v_and_b32 v171, s55, v205
    v_pk_fma_f32 v[168:169], v[168:169], v[220:221], v[220:221] op_sel:[0,1,0] op_sel_hi:[1,1,0]
    v_pk_fma_f32 v[170:171], v[170:171], v[220:221], v[220:221] op_sel:[0,1,0] op_sel_hi:[1,1,0]
    s_waitcnt lgkmcnt(0)
    v_add_f32 v72, v72, v73
    v_add_f32 v74, v74, v75
    v_add_f32 v76, v76, v77
    v_add_f32 v78, v78, v79
    v_add_f32 v72, v72, v74
    v_add_f32 v76, v76, v78
    v_mfma_f32_16x16x32_bf16 v[228:231], v[52:55], v[104:107], 0
    s_mov_b32 s40, 0x21800000
    v_mfma_f32_16x16x32_bf16 v[228:231], v[52:55], v[108:111], v[228:231]
    s_mov_b32 s41, 0x5d800000
    v_cmp_le_f32 s[56:57], s40, v72
    v_mfma_f32_16x16x32_bf16 v[232:235], v[52:55], v[112:115], 0
    v_cmp_ge_f32 vcc, s41, v72
    v_rcp_f32 v73, v72
    v_mfma_f32_16x16x32_bf16 v[232:235], v[52:55], v[116:119], v[232:235]
    s_nop 0
    s_and_b64 s[56:57], s[56:57], vcc
    s_waitcnt vmcnt(2)
    v_lshlrev_b32 v156, 16, v206
    v_and_b32 v157, s55, v206
    v_mfma_f32_16x16x32_bf16 v[236:239], v[52:55], v[120:123], 0
    v_cmp_le_f32 vcc, s40, v76
    v_lshlrev_b32 v158, 16, v207
    v_and_b32 v159, s55, v207
    v_mfma_f32_16x16x32_bf16 v[236:239], v[52:55], v[124:127], v[236:239]
    v_rcp_f32 v77, v76
    s_waitcnt vmcnt(0)
    v_pk_fma_f32 v[156:157], v[156:157], v[222:223], v[222:223] op_sel:[0,1,0] op_sel_hi:[1,1,0]
    v_pk_fma_f32 v[158:159], v[158:159], v[222:223], v[222:223] op_sel:[0,1,0] op_sel_hi:[1,1,0]
    s_nop 1
    v_mfma_f32_16x16x32_bf16 v[240:243], v[52:55], v[128:131], 0
    s_and_b64 s[56:57], s[56:57], vcc
    v_lshlrev_b32 v164, 16, v208
    v_and_b32 v165, s55, v208
    v_mfma_f32_16x16x32_bf16 v[240:243], v[52:55], v[132:135], v[240:243]
    v_cmp_ge_f32 vcc, s41, v76
    v_lshlrev_b32 v166, 16, v209
    v_and_b32 v167, s55, v209
    v_mfma_f32_16x16x32_bf16 v[244:247], v[52:55], v[136:139], 0
    s_and_b64 s[56:57], s[56:57], vcc
    v_pk_fma_f32 v[164:165], v[164:165], v[222:223], v[222:223] op_sel:[0,1,0] op_sel_hi:[1,1,0]
    v_pk_fma_f32 v[166:167], v[166:167], v[222:223], v[222:223] op_sel:[0,1,0] op_sel_hi:[1,1,0]
    s_nop 1
    v_mfma_f32_16x16x32_bf16 v[244:247], v[52:55], v[140:143], v[244:247]
    s_cmp_eq_u64 s[56:57], -1
    v_lshlrev_b32 v172, 16, v210
    v_and_b32 v173, s55, v210
    v_mfma_f32_16x16x32_bf16 v[248:251], v[52:55], v[144:147], 0
    s_cselect_b32 s40, 1, s54
    v_lshlrev_b32 v174, 16, v211
    v_and_b32 v175, s55, v211
    v_mfma_f32_16x16x32_bf16 v[248:251], v[52:55], v[148:151], v[248:251]
    v_pk_fma_f32 v[172:173], v[172:173], v[222:223], v[222:223] op_sel:[0,1,0] op_sel_hi:[1,1,0]
    v_pk_fma_f32 v[174:175], v[174:175], v[222:223], v[222:223] op_sel:[0,1,0] op_sel_hi:[1,1,0]
    s_cmp_eq_u32 s40, 0
    s_cbranch_scc1 K2_slow
    v_pk_mul_f32 v[228:229], v[228:229], v[72:73] op_sel:[0,1] op_sel_hi:[1,1]
    v_pk_mul_f32 v[230:231], v[230:231], v[72:73] op_sel:[0,1] op_sel_hi:[1,1]
    v_cvt_pk_bf16_f32 v56, v228, v229
    v_cvt_pk_bf16_f32 v57, v230, v231
    ds_write_b64 v28, v[56:57] offset:0
    v_pk_mul_f32 v[232:233], v[232:233], v[76:77] op_sel:[0,1] op_sel_hi:[1,1]
    v_pk_mul_f32 v[234:235], v[234:235], v[76:77] op_sel:[0,1] op_sel_hi:[1,1]
    v_cvt_pk_bf16_f32 v58, v232, v233
    v_cvt_pk_bf16_f32 v59, v234, v235
    ds_write_b64 v28, v[58:59] offset:6144
    v_pk_mul_f32 v[236:237], v[236:237], v[72:73] op_sel:[0,1] op_sel_hi:[1,1]
    v_pk_mul_f32 v[238:239], v[238:239], v[72:73] op_sel:[0,1] op_sel_hi:[1,1]
    v_cvt_pk_bf16_f32 v60, v236, v237
    v_cvt_pk_bf16_f32 v61, v238, v239
    ds_write_b64 v29, v[60:61] offset:0
    v_pk_mul_f32 v[240:241], v[240:241], v[76:77] op_sel:[0,1] op_sel_hi:[1,1]
    v_pk_mul_f32 v[242:243], v[242:243], v[76:77] op_sel:[0,1] op_sel_hi:[1,1]
    v_cvt_pk_bf16_f32 v62, v240, v241
    v_cvt_pk_bf16_f32 v63, v242, v243
    ds_write_b64 v29, v[62:63] offset:6144
    v_pk_mul_f32 v[244:245], v[244:245], v[72:73] op_sel:[0,1] op_sel_hi:[1,1]
    v_pk_mul_f32 v[246:247], v[246:247], v[72:73] op_sel:[0,1] op_sel_hi:[1,1]
    s_waitcnt lgkmcnt(2)
    v_cvt_pk_bf16_f32 v56, v244, v245
    v_cvt_pk_bf16_f32 v57, v246, v247
    ds_write_b64 v30, v[56:57] offset:0
    v_pk_mul_f32 v[248:249], v[248:249], v[76:77] op_sel:[0,1] op_sel_hi:[1,1]
    v_pk_mul_f32 v[250:251], v[250:251], v[76:77] op_sel:[0,1] op_sel_hi:[1,1]
    v_cvt_pk_bf16_f32 v58, v248, v249
    v_cvt_pk_bf16_f32 v59, v250, v251
    ds_write_b64 v30, v[58:59] offset:6144
    s_waitcnt lgkmcnt(0)
    s_barrier
    ds_read_b128 v[104:107], v31 offset:0
    ds_read_b128 v[108:111], v32 offset:0
    ds_read_b128 v[112:115], v31 offset:128
    ds_read_b128 v[116:119], v32 offset:128
    ds_read_b128 v[120:123], v31 offset:256
    ds_read_b128 v[124:127], v32 offset:256
    ds_read_b128 v[128:131], v31 offset:6144
    ds_read_b128 v[132:135], v32 offset:6144
    ds_read_b128 v[136:139], v31 offset:6272
    ds_read_b128 v[140:143], v32 offset:6272
    ds_read_b128 v[144:147], v31 offset:6400
    ds_read_b128 v[148:151], v32 offset:6400
    s_waitcnt lgkmcnt(9)
    v_mfma_f32_16x16x32_bf16 v[152:155], a[192:195], v[104:107], v[152:155]
    v_mfma_f32_16x16x32_bf16 v[160:163], a[196:199], v[104:107], v[160:163]
    v_mfma_f32_16x16x32_bf16 v[168:171], a[200:203], v[104:107], v[168:171]
    v_mfma_f32_16x16x32_bf16 v[152:155], a[204:207], v[108:111], v[152:155]
    v_mfma_f32_16x16x32_bf16 v[160:163], a[208:211], v[108:111], v[160:163]
    v_mfma_f32_16x16x32_bf16 v[168:171], a[212:215], v[108:111], v[168:171]
    v_mfma_f32_16x16x32_bf16 v[152:155], a[216:219], v[112:115], v[152:155]
    v_mfma_f32_16x16x32_bf16 v[160:163], a[220:223], v[112:115], v[160:163]
    v_mfma_f32_16x16x32_bf16 v[168:171], a[224:227], v[112:115], v[168:171]
    s_waitcnt lgkmcnt(0)
    v_mfma_f32_16x16x32_bf16 v[152:155], a[228:231], v[116:119], v[152:155]
    v_mfma_f32_16x16x32_bf16 v[160:163], a[232:235], v[116:119], v[160:163]
    v_mfma_f32_16x16x32_bf16 v[168:171], a[236:239], v[116:119], v[168:171]
    v_mfma_f32_16x16x32_bf16 v[152:155], a[240:243], v[120:123], v[152:155]
    v_mfma_f32_16x16x32_bf16 v[160:163], a[244:247], v[120:123], v[160:163]
    v_mfma_f32_16x16x32_bf16 v[168:171], a[248:251], v[120:123], v[168:171]
    v_mfma_f32_16x16x32_bf16 v[152:155], a[252:255], v[124:127], v[152:155]
    v_mfma_f32_16x16x32_bf16 v[160:163], v[212:215], v[124:127], v[160:163]
    v_mfma_f32_16x16x32_bf16 v[168:171], v[216:219], v[124:127], v[168:171]
    v_mfma_f32_16x16x32_bf16 v[156:159], a[192:195], v[128:131], v[156:159]
    v_mfma_f32_16x16x32_bf16 v[164:167], a[196:199], v[128:131], v[164:167]
    v_mfma_f32_16x16x32_bf16 v[172:175], a[200:203], v[128:131], v[172:175]
    v_mfma_f32_16x16x32_bf16 v[156:159], a[204:207], v[132:135], v[156:159]
    s_nop 1
    v_cvt_pk_bf16_f32 v56, v152, v153
    v_mfma_f32_16x16x32_bf16 v[164:167], a[208:211], v[132:135], v[164:167]
    v_cvt_pk_bf16_f32 v57, v154, v155
    v_mfma_f32_16x16x32_bf16 v[172:175], a[212:215], v[132:135], v[172:175]
    v_cvt_pk_bf16_f32 v58, v160, v161
    v_mfma_f32_16x16x32_bf16 v[156:159], a[216:219], v[136:139], v[156:159]
    v_cvt_pk_bf16_f32 v59, v162, v163
    v_mfma_f32_16x16x32_bf16 v[164:167], a[220:223], v[136:139], v[164:167]
    v_cvt_pk_bf16_f32 v60, v168, v169
    v_mfma_f32_16x16x32_bf16 v[172:175], a[224:227], v[136:139], v[172:175]
    v_cvt_pk_bf16_f32 v61, v170, v171
    v_mfma_f32_16x16x32_bf16 v[156:159], a[228:231], v[140:143], v[156:159]
    ds_write_b128 v33, v[56:59] offset:0
    v_mfma_f32_16x16x32_bf16 v[164:167], a[232:235], v[140:143], v[164:167]
    ds_write_b64 v34, v[60:61] offset:0
    v_mfma_f32_16x16x32_bf16 v[172:175], a[236:239], v[140:143], v[172:175]
    v_mfma_f32_16x16x32_bf16 v[156:159], a[240:243], v[144:147], v[156:159]
    v_mfma_f32_16x16x32_bf16 v[164:167], a[244:247], v[144:147], v[164:167]
    v_mfma_f32_16x16x32_bf16 v[172:175], a[248:251], v[144:147], v[172:175]
    v_mfma_f32_16x16x32_bf16 v[156:159], a[252:255], v[148:151], v[156:159]
    v_mfma_f32_16x16x32_bf16 v[164:167], v[212:215], v[148:151], v[164:167]
    v_mfma_f32_16x16x32_bf16 v[172:175], v[216:219], v[148:151], v[172:175]
    s_nop 5
    v_cvt_pk_bf16_f32 v72, v156, v157
    v_cvt_pk_bf16_f32 v73, v158, v159
    v_cvt_pk_bf16_f32 v74, v164, v165
    v_cvt_pk_bf16_f32 v75, v166, v167
    v_cvt_pk_bf16_f32 v76, v172, v173
    v_cvt_pk_bf16_f32 v77, v174, v175
    ds_write_b128 v33, v[72:75] offset:6144
    ds_write_b64 v34, v[76:77] offset:6144
    s_waitcnt lgkmcnt(0)
    s_barrier
    ds_read_b128 v[104:107], v35 offset:0
    ds_read_b128 v[108:111], v35 offset:128
    ds_read_b128 v[112:115], v35 offset:256
    s_waitcnt lgkmcnt(2)
    buffer_store_dwordx4 v[104:107], v36, s[28:31], 0 offen offset:0 sc1
    s_waitcnt lgkmcnt(1)
    buffer_store_dwordx4 v[108:111], v36, s[28:31], 0 offen offset:128 sc1
    s_waitcnt lgkmcnt(0)
    buffer_store_dwordx4 v[112:115], v36, s[28:31], 0 offen offset:256 sc1
    s_endpgm
K2_slow:
    s_waitcnt vmcnt(0) lgkmcnt(0)
    s_barrier
    s_mov_b32 s54, 1
    s_mov_b32 s58, 0
    v_mov_b32 v40, 0xff800000
K2_mx:
    s_lshl_b32 s40, s58, 2
    s_add_u32 s40, s40, s36
    s_cmp_ge_u32 s40, 23
    s_cbranch_scc1 K2_mx_done
    s_add_u32 s40, s40, s37
    s_cmp_ge_u32 s40, 23
    s_cselect_b32 s41, 23, 0
    s_sub_u32 s40, s40, s41
    s_mul_i32 s59, s40, 12288
    s_add_u32 m0, s50, 0
    s_nop 0
    buffer_load_dwordx4 v12, s[20:23], s59 offen offset:0 lds
    buffer_load_dwordx4 v12, s[20:23], s59 offen offset:1024 lds
    buffer_load_dwordx4 v12, s[20:23], s59 offen offset:2048 lds
    buffer_load_dwordx4 v12, s[20:23], s59 offen offset:3072 lds
    s_add_u32 m0, s50, 4096
    s_nop 0
    buffer_load_dwordx4 v13, s[20:23], s59 offen offset:0 lds
    buffer_load_dwordx4 v13, s[20:23], s59 offen offset:1024 lds
    buffer_load_dwordx4 v13, s[20:23], s59 offen offset:2048 lds
    buffer_load_dwordx4 v13, s[20:23], s59 offen offset:3072 lds
    s_add_u32 m0, s50, 8192
    s_nop 0
    buffer_load_dwordx4 v14, s[20:23], s59 offen offset:0 lds
    buffer_load_dwordx4 v14, s[20:23], s59 offen offset:1024 lds
    buffer_load_dwordx4 v14, s[20:23], s59 offen offset:2048 lds
    buffer_load_dwordx4 v14, s[20:23], s59 offen offset:3072 lds
    s_waitcnt vmcnt(0)
    ds_read_b128 a[48:51], v4 offset:0
    ds_read_b128 a[52:55], v5 offset:0
    ds_read_b128 a[56:59], v6 offset:0
    ds_read_b128 a[60:63], v7 offset:0
    ds_read_b128 a[64:67], v4 offset:128
    ds_read_b128 a[68:71], v5 offset:128
    ds_read_b128 a[72:75], v6 offset:128
    ds_read_b128 a[76:79], v7 offset:128
    ds_read_b128 a[80:83], v4 offset:256
    ds_read_b128 a[84:87], v5 offset:256
    ds_read_b128 a[88:91], v6 offset:256
    ds_read_b128 a[92:95], v7 offset:256
    s_waitcnt lgkmcnt(9)
    v_mfma_f32_32x32x16_bf16 v[72:87], a[48:51], a[0:3], 0
    v_mfma_f32_32x32x16_bf16 v[72:87], a[52:55], a[4:7], v[72:87]
    v_mfma_f32_32x32x16_bf16 v[72:87], a[56:59], a[8:11], v[72:87]
    s_waitcnt lgkmcnt(5)
    v_mfma_f32_32x32x16_bf16 v[72:87], a[60:63], a[12:15], v[72:87]
    v_mfma_f32_32x32x16_bf16 v[72:87], a[64:67], a[16:19], v[72:87]
    v_mfma_f32_32x32x16_bf16 v[72:87], a[68:71], a[20:23], v[72:87]
    v_mfma_f32_32x32x16_bf16 v[72:87], a[72:75], a[24:27], v[72:87]
    s_waitcnt lgkmcnt(0)
    v_mfma_f32_32x32x16_bf16 v[72:87], a[76:79], a[28:31], v[72:87]
    v_mfma_f32_32x32x16_bf16 v[72:87], a[80:83], a[32:35], v[72:87]
    v_mfma_f32_32x32x16_bf16 v[72:87], a[84:87], a[36:39], v[72:87]
    v_mfma_f32_32x32x16_bf16 v[72:87], a[88:91], a[40:43], v[72:87]
    v_mfma_f32_32x32x16_bf16 v[72:87], a[92:95], a[44:47], v[72:87]
    s_nop 15
    s_cmp_eq_u32 s59, 270336
    s_cbranch_scc0 BK2_msk_13
    v_mov_b32 v48, 0xff800000
    v_cndmask_b32 v84, v84, v48, s[52:53]
    v_mov_b32 v85, 0xff800000
    v_mov_b32 v86, 0xff800000
    v_mov_b32 v87, 0xff800000
BK2_msk_13:
    v_max3_f32 v40, v40, v72, v73
    v_max3_f32 v40, v40, v74, v75
    v_max3_f32 v40, v40, v76, v77
    v_max3_f32 v40, v40, v78, v79
    v_max3_f32 v40, v40, v80, v81
    v_max3_f32 v40, v40, v82, v83
    v_max3_f32 v40, v40, v84, v85
    v_max3_f32 v40, v40, v86, v87
    s_waitcnt lgkmcnt(0)
    s_add_u32 s58, s58, 1
    s_branch K2_mx
K2_mx_done:
    v_mov_b32 v41, v40
    s_nop 1
    v_permlane32_swap_b32 v40, v41
    v_max_f32 v40, v40, v41
    v_add_u32 v44, 512, v38
    ds_write_b32 v44, v40
    s_waitcnt lgkmcnt(0)
    s_barrier
    v_and_b32 v44, 31, v1
    v_lshlrev_b32 v44, 4, v44
    v_add_u32 v44, 160256, v44
    ds_read_b128 v[72:75], v44
    s_waitcnt lgkmcnt(0)
    v_max3_f32 v72, v72, v73, v74
    v_max_f32 v72, v72, v75
    v_sub_f32 v228, 0, v72
    v_sub_f32 v229, 0, v72
    v_sub_f32 v230, 0, v72
    v_sub_f32 v231, 0, v72
    v_sub_f32 v232, 0, v72
    v_sub_f32 v233, 0, v72
    v_sub_f32 v234, 0, v72
    v_sub_f32 v235, 0, v72
    v_sub_f32 v236, 0, v72
    v_sub_f32 v237, 0, v72
    v_sub_f32 v238, 0, v72
    v_sub_f32 v239, 0, v72
    v_sub_f32 v240, 0, v72
    v_sub_f32 v241, 0, v72
    v_sub_f32 v242, 0, v72
    v_sub_f32 v243, 0, v72
    v_mov_b32 v104, 0
    v_mov_b32 v105, 0
    v_mov_b32 v106, 0
    v_mov_b32 v107, 0
    v_mov_b32 v108, 0
    v_mov_b32 v109, 0
    v_mov_b32 v110, 0
    v_mov_b32 v111, 0
    v_mov_b32 v112, 0
    v_mov_b32 v113, 0
    v_mov_b32 v114, 0
    v_mov_b32 v115, 0
    v_mov_b32 v116, 0
    v_mov_b32 v117, 0
    v_mov_b32 v118, 0
    v_mov_b32 v119, 0
    v_mov_b32 v120, 0
    v_mov_b32 v121, 0
    v_mov_b32 v122, 0
    v_mov_b32 v123, 0
    v_mov_b32 v124, 0
    v_mov_b32 v125, 0
    v_mov_b32 v126, 0
    v_mov_b32 v127, 0
    v_mov_b32 v128, 0
    v_mov_b32 v129, 0
    v_mov_b32 v130, 0
    v_mov_b32 v131, 0
    v_mov_b32 v132, 0
    v_mov_b32 v133, 0
    v_mov_b32 v134, 0
    v_mov_b32 v135, 0
    v_mov_b32 v136, 0
    v_mov_b32 v137, 0
    v_mov_b32 v138, 0
    v_mov_b32 v139, 0
    v_mov_b32 v140, 0
    v_mov_b32 v141, 0
    v_mov_b32 v142, 0
    v_mov_b32 v143, 0
    v_mov_b32 v144, 0
    v_mov_b32 v145, 0
    v_mov_b32 v146, 0
    v_mov_b32 v147, 0
    v_mov_b32 v148, 0
    v_mov_b32 v149, 0
    v_mov_b32 v150, 0
    v_mov_b32 v151, 0
    v_mov_b32 v152, 0
    v_mov_b32 v153, 0
    v_mov_b32 v154, 0
    v_mov_b32 v155, 0
    v_mov_b32 v156, 0
    v_mov_b32 v157, 0
    v_mov_b32 v158, 0
    v_mov_b32 v159, 0
    v_mov_b32 v160, 0
    v_mov_b32 v161, 0
    v_mov_b32 v162, 0
    v_mov_b32 v163, 0
    v_mov_b32 v164, 0
    v_mov_b32 v165, 0
    v_mov_b32 v166, 0
    v_mov_b32 v167, 0
    v_mov_b32 v168, 0
    v_mov_b32 v169, 0
    v_mov_b32 v170, 0
    v_mov_b32 v171, 0
    v_mov_b32 v172, 0
    v_mov_b32 v173, 0
    v_mov_b32 v174, 0
    v_mov_b32 v175, 0
    v_mov_b32 v176, 0
    v_mov_b32 v177, 0
    v_mov_b32 v178, 0
    v_mov_b32 v179, 0
    v_mov_b32 v180, 0
    v_mov_b32 v181, 0
    v_mov_b32 v182, 0
    v_mov_b32 v183, 0
    v_mov_b32 v184, 0
    v_mov_b32 v185, 0
    v_mov_b32 v186, 0
    v_mov_b32 v187, 0
    v_mov_b32 v188, 0
    v_mov_b32 v189, 0
    v_mov_b32 v190, 0
    v_mov_b32 v191, 0
    v_mov_b32 v192, 0
    v_mov_b32 v193, 0
    v_mov_b32 v194, 0
    v_mov_b32 v195, 0
    v_mov_b32 v196, 0
    v_mov_b32 v197, 0
    v_mov_b32 v198, 0
    v_mov_b32 v199, 0
    v_mov_b32 v40, 0
    v_mov_b32 v41, 0
    s_mov_b32 s58, 0
K2_sl:
    s_lshl_b32 s40, s58, 2
    s_add_u32 s40, s40, s36
    s_cmp_ge_u32 s40, 23
    s_cbranch_scc1 K2_sl_done
    s_add_u32 s40, s40, s37
    s_cmp_ge_u32 s40, 23
    s_cselect_b32 s41, 23, 0
    s_sub_u32 s40, s40, s41
    s_mul_i32 s59, s40, 12288
    s_add_u32 m0, s50, 0
    s_nop 0
    buffer_load_dwordx4 v12, s[20:23], s59 offen offset:0 lds
    buffer_load_dwordx4 v12, s[20:23], s59 offen offset:1024 lds
    buffer_load_dwordx4 v12, s[20:23], s59 offen offset:2048 lds
    buffer_load_dwordx4 v12, s[20:23], s59 offen offset:3072 lds
    s_add_u32 m0, s50, 4096
    s_nop 0
    buffer_load_dwordx4 v13, s[20:23], s59 offen offset:0 lds
    buffer_load_dwordx4 v13, s[20:23], s59 offen offset:1024 lds
    buffer_load_dwordx4 v13, s[20:23], s59 offen offset:2048 lds
    buffer_load_dwordx4 v13, s[20:23], s59 offen offset:3072 lds
    s_add_u32 m0, s50, 8192
    s_nop 0
    buffer_load_dwordx4 v14, s[20:23], s59 offen offset:0 lds
    buffer_load_dwordx4 v14, s[20:23], s59 offen offset:1024 lds
    buffer_load_dwordx4 v14, s[20:23], s59 offen offset:2048 lds
    buffer_load_dwordx4 v14, s[20:23], s59 offen offset:3072 lds
    s_waitcnt vmcnt(0)
    ds_read_b128 a[48:51], v4 offset:0
    ds_read_b128 a[52:55], v5 offset:0
    ds_read_b128 a[56:59], v6 offset:0
    ds_read_b128 a[60:63], v7 offset:0
    ds_read_b128 a[64:67], v4 offset:128
    ds_read_b128 a[68:71], v5 offset:128
    ds_read_b128 a[72:75], v6 offset:128
    ds_read_b128 a[76:79], v7 offset:128
    ds_read_b128 a[80:83], v4 offset:256
    ds_read_b128 a[84:87], v5 offset:256
    ds_read_b128 a[88:91], v6 offset:256
    ds_read_b128 a[92:95], v7 offset:256
    s_waitcnt lgkmcnt(9)
    v_mfma_f32_32x32x16_bf16 v[72:87], a[48:51], a[0:3], v[228:243]
    v_mfma_f32_32x32x16_bf16 v[72:87], a[52:55], a[4:7], v[72:87]
    v_mfma_f32_32x32x16_bf16 v[72:87], a[56:59], a[8:11], v[72:87]
    s_waitcnt lgkmcnt(5)
    v_mfma_f32_32x32x16_bf16 v[72:87], a[60:63], a[12:15], v[72:87]
    v_mfma_f32_32x32x16_bf16 v[72:87], a[64:67], a[16:19], v[72:87]
    v_mfma_f32_32x32x16_bf16 v[72:87], a[68:71], a[20:23], v[72:87]
    v_mfma_f32_32x32x16_bf16 v[72:87], a[72:75], a[24:27], v[72:87]
    s_waitcnt lgkmcnt(0)
    v_mfma_f32_32x32x16_bf16 v[72:87], a[76:79], a[28:31], v[72:87]
    v_mfma_f32_32x32x16_bf16 v[72:87], a[80:83], a[32:35], v[72:87]
    v_mfma_f32_32x32x16_bf16 v[72:87], a[84:87], a[36:39], v[72:87]
    v_mfma_f32_32x32x16_bf16 v[72:87], a[88:91], a[40:43], v[72:87]
    v_mfma_f32_32x32x16_bf16 v[72:87], a[92:95], a[44:47], v[72:87]
    s_nop 15
    v_exp_f32 v72, v72
    v_exp_f32 v73, v73
    v_exp_f32 v74, v74
    v_exp_f32 v75, v75
    v_exp_f32 v76, v76
    v_exp_f32 v77, v77
    v_exp_f32 v78, v78
    v_exp_f32 v79, v79
    v_exp_f32 v80, v80
    v_exp_f32 v81, v81
    v_exp_f32 v82, v82
    v_exp_f32 v83, v83
    v_exp_f32 v84, v84
    v_exp_f32 v85, v85
    v_exp_f32 v86, v86
    v_exp_f32 v87, v87
    s_cmp_eq_u32 s59, 270336
    s_cbranch_scc0 BK2_msk_14
    v_mov_b32 v48, 0
    v_cndmask_b32 v84, v84, v48, s[52:53]
    v_mov_b32 v85, 0
    v_mov_b32 v86, 0
    v_mov_b32 v87, 0
BK2_msk_14:
    v_add_f32 v40, v40, v72
    v_add_f32 v41, v41, v73
    v_add_f32 v40, v40, v74
    v_add_f32 v41, v41, v75
    v_add_f32 v40, v40, v76
    v_add_f32 v41, v41, v77
    v_add_f32 v40, v40, v78
    v_add_f32 v41, v41, v79
    v_add_f32 v40, v40, v80
    v_add_f32 v41, v41, v81
    v_add_f32 v40, v40, v82
    v_add_f32 v41, v41, v83
    v_add_f32 v40, v40, v84
    v_add_f32 v41, v41, v85
    v_add_f32 v40, v40, v86
    v_add_f32 v41, v41, v87
    v_cvt_pk_bf16_f32 v56, v72, v73
    v_cvt_pk_bf16_f32 v57, v74, v75
    v_cvt_pk_bf16_f32 v58, v76, v77
    v_cvt_pk_bf16_f32 v59, v78, v79
    v_cvt_pk_bf16_f32 v60, v80, v81
    v_cvt_pk_bf16_f32 v61, v82, v83
    v_cvt_pk_bf16_f32 v62, v84, v85
    v_cvt_pk_bf16_f32 v63, v86, v87
    ds_read_b64_tr_b16 a[96:97], v8 offset:0
    ds_read_b64_tr_b16 a[98:99], v9 offset:0
    ds_read_b64_tr_b16 a[100:101], v10 offset:0
    ds_read_b64_tr_b16 a[102:103], v11 offset:0
    ds_read_b64_tr_b16 a[104:105], v8 offset:128
    ds_read_b64_tr_b16 a[106:107], v9 offset:128
    ds_read_b64_tr_b16 a[108:109], v10 offset:128
    ds_read_b64_tr_b16 a[110:111], v11 offset:128
    ds_read_b64_tr_b16 a[112:113], v8 offset:256
    ds_read_b64_tr_b16 a[114:115], v9 offset:256
    ds_read_b64_tr_b16 a[116:117], v10 offset:256
    ds_read_b64_tr_b16 a[118:119], v11 offset:256
    ds_read_b64_tr_b16 a[120:121], v8 offset:6144
    ds_read_b64_tr_b16 a[122:123], v9 offset:6144
    ds_read_b64_tr_b16 a[124:125], v10 offset:6144
    ds_read_b64_tr_b16 a[126:127], v11 offset:6144
    ds_read_b64_tr_b16 a[128:129], v8 offset:6272
    ds_read_b64_tr_b16 a[130:131], v9 offset:6272
    ds_read_b64_tr_b16 a[132:133], v10 offset:6272
    ds_read_b64_tr_b16 a[134:135], v11 offset:6272
    ds_read_b64_tr_b16 a[136:137], v8 offset:6400
    ds_read_b64_tr_b16 a[138:139], v9 offset:6400
    ds_read_b64_tr_b16 a[140:141], v10 offset:6400
    ds_read_b64_tr_b16 a[142:143], v11 offset:6400
    s_waitcnt lgkmcnt(9)
    v_mfma_f32_32x32x16_bf16 v[104:119], a[96:99], v[56:59], v[104:119]
    v_mfma_f32_32x32x16_bf16 v[120:135], a[100:103], v[56:59], v[120:135]
    v_mfma_f32_32x32x16_bf16 v[136:151], a[104:107], v[56:59], v[136:151]
    v_mfma_f32_32x32x16_bf16 v[152:167], a[108:111], v[56:59], v[152:167]
    v_mfma_f32_32x32x16_bf16 v[168:183], a[112:115], v[56:59], v[168:183]
    v_mfma_f32_32x32x16_bf16 v[184:199], a[116:119], v[56:59], v[184:199]
    v_mfma_f32_32x32x16_bf16 v[104:119], a[120:123], v[60:63], v[104:119]
    s_waitcnt lgkmcnt(1)
    v_mfma_f32_32x32x16_bf16 v[120:135], a[124:127], v[60:63], v[120:135]
    v_mfma_f32_32x32x16_bf16 v[136:151], a[128:131], v[60:63], v[136:151]
    v_mfma_f32_32x32x16_bf16 v[152:167], a[132:135], v[60:63], v[152:167]
    v_mfma_f32_32x32x16_bf16 v[168:183], a[136:139], v[60:63], v[168:183]
    s_waitcnt lgkmcnt(0)
    v_mfma_f32_32x32x16_bf16 v[184:199], a[140:143], v[60:63], v[184:199]
    s_waitcnt lgkmcnt(0)
    s_add_u32 s58, s58, 1
    s_branch K2_sl
K2_sl_done:
    s_nop 15
    v_add_f32 v40, v40, v41
    v_mov_b32 v41, v40
    s_nop 1
    v_permlane32_swap_b32 v40, v41
    v_add_f32 v40, v40, v41
    ds_write_b32 v38, v40
    v_cvt_pk_bf16_f32 v88, v104, v105
    v_cvt_pk_bf16_f32 v89, v106, v107
    v_cvt_pk_bf16_f32 v90, v108, v109
    v_cvt_pk_bf16_f32 v91, v110, v111
    ds_write_b128 v21, v[88:91] offset:0
    v_cvt_pk_bf16_f32 v92, v112, v113
    v_cvt_pk_bf16_f32 v93, v114, v115
    v_cvt_pk_bf16_f32 v94, v116, v117
    v_cvt_pk_bf16_f32 v95, v118, v119
    ds_write_b128 v22, v[92:95] offset:0
    v_cvt_pk_bf16_f32 v96, v120, v121
    v_cvt_pk_bf16_f32 v97, v122, v123
    v_cvt_pk_bf16_f32 v98, v124, v125
    v_cvt_pk_bf16_f32 v99, v126, v127
    ds_write_b128 v23, v[96:99] offset:0
    v_cvt_pk_bf16_f32 v100, v128, v129
    v_cvt_pk_bf16_f32 v101, v130, v131
    v_cvt_pk_bf16_f32 v102, v132, v133
    v_cvt_pk_bf16_f32 v103, v134, v135
    ds_write_b128 v24, v[100:103] offset:0
    s_waitcnt lgkmcnt(2)
    v_cvt_pk_bf16_f32 v88, v136, v137
    v_cvt_pk_bf16_f32 v89, v138, v139
    v_cvt_pk_bf16_f32 v90, v140, v141
    v_cvt_pk_bf16_f32 v91, v142, v143
    ds_write_b128 v21, v[88:91] offset:128
    v_cvt_pk_bf16_f32 v92, v144, v145
    v_cvt_pk_bf16_f32 v93, v146, v147
    v_cvt_pk_bf16_f32 v94, v148, v149
    v_cvt_pk_bf16_f32 v95, v150, v151
    ds_write_b128 v22, v[92:95] offset:128
    s_waitcnt lgkmcnt(2)
    v_cvt_pk_bf16_f32 v96, v152, v153
    v_cvt_pk_bf16_f32 v97, v154, v155
    v_cvt_pk_bf16_f32 v98, v156, v157
    v_cvt_pk_bf16_f32 v99, v158, v159
    ds_write_b128 v23, v[96:99] offset:128
    v_cvt_pk_bf16_f32 v100, v160, v161
    v_cvt_pk_bf16_f32 v101, v162, v163
    v_cvt_pk_bf16_f32 v102, v164, v165
    v_cvt_pk_bf16_f32 v103, v166, v167
    ds_write_b128 v24, v[100:103] offset:128
    s_waitcnt lgkmcnt(2)
    v_cvt_pk_bf16_f32 v88, v168, v169
    v_cvt_pk_bf16_f32 v89, v170, v171
    v_cvt_pk_bf16_f32 v90, v172, v173
    v_cvt_pk_bf16_f32 v91, v174, v175
    ds_write_b128 v21, v[88:91] offset:256
    v_cvt_pk_bf16_f32 v92, v176, v177
    v_cvt_pk_bf16_f32 v93, v178, v179
    v_cvt_pk_bf16_f32 v94, v180, v181
    v_cvt_pk_bf16_f32 v95, v182, v183
    ds_write_b128 v22, v[92:95] offset:256
    s_waitcnt lgkmcnt(2)
    v_cvt_pk_bf16_f32 v96, v184, v185
    v_cvt_pk_bf16_f32 v97, v186, v187
    v_cvt_pk_bf16_f32 v98, v188, v189
    v_cvt_pk_bf16_f32 v99, v190, v191
    ds_write_b128 v23, v[96:99] offset:256
    v_cvt_pk_bf16_f32 v100, v192, v193
    v_cvt_pk_bf16_f32 v101, v194, v195
    v_cvt_pk_bf16_f32 v102, v196, v197
    v_cvt_pk_bf16_f32 v103, v198, v199
    ds_write_b128 v24, v[100:103] offset:256
    s_waitcnt lgkmcnt(0)
    s_barrier
    s_branch K2_reduce
K2_done:
    s_endpgm
TEXT_end:
.section .rodata,"a"
.p2align 6
.amdhsa_kernel tsf_temporal_kernel
  .amdhsa_next_free_vgpr 272
  .amdhsa_next_free_sgpr 102
  .amdhsa_accum_offset 256
  .amdhsa_group_segment_fixed_size 0
  .amdhsa_kernarg_size 64
  .amdhsa_user_sgpr_count 2
  .amdhsa_user_sgpr_kernarg_segment_ptr 1
  .amdhsa_system_sgpr_workgroup_id_x 1
  .amdhsa_float_denorm_mode_32 3
.end_amdhsa_kernel
.section .rodata,"a"
.p2align 6
.amdhsa_kernel tsf_spatial_kernel
  .amdhsa_next_free_vgpr 512
  .amdhsa_next_free_sgpr 102
  .amdhsa_accum_offset 256
  .amdhsa_group_segment_fixed_size 0
  .amdhsa_kernarg_size 64
  .amdhsa_user_sgpr_count 2
  .amdhsa_user_sgpr_kernarg_segment_ptr 1
  .amdhsa_system_sgpr_workgroup_id_x 1
  .amdhsa_float_denorm_mode_32 3
.end_amdhsa_kernel
```
